```python
import torch

def _softmax(x, axis=-1):
    return torch.softmax(x, dim=axis)
def _gelu(x):
    return torch.nn.functional.gelu(x, approximate="tanh")
def _silu(x):
    return torch.nn.functional.silu(x)
def _sigmoid(x):
    return torch.sigmoid(x)
def _layernorm(x, axis=-1, eps=1e-5):
    m = x.mean(dim=axis, keepdim=True)
    v = x.var(dim=axis, keepdim=True, unbiased=False)
    return (x - m) / torch.sqrt(v + eps)
def _scatter_add(tgt, idx, src, axis=0):
    return tgt.clone().index_add_(axis, idx, src)
def _segment_sum(src, seg, n):
    out = torch.zeros((n,) + src.shape[1:], dtype=src.dtype)
    return out.index_add_(0, seg, src)
def _pad(x, pw):
    flat = tuple(v for pair in reversed(pw) for v in pair)
    return torch.nn.functional.pad(x, flat)

kernel_name = 'concat_heads__ssm_conv_s4d__ssm_conv_h3__prompt'

def setup_inputs():

    _w = (lambda a: (lambda t: t.to(torch.bfloat16) if t.is_floating_point() else t)(torch.as_tensor(a)))
    def _A_setup():
        Bsz, L, D, N = 1, 2048, 640, 192
        return {
            "u": _w((lambda *s: torch.randn(*s, dtype=torch.bfloat16) * 0.05)(Bsz, L, D)),
            "log_A_real": _w((lambda *s: torch.randn(*s, dtype=torch.bfloat16) * 3.2)(D, N) * 0.5),
            "A_imag": _w((lambda *s: torch.randn(*s, dtype=torch.bfloat16) * 0.05)(D, N) * 3.14),
            "C_real": _w((lambda *s: torch.randn(*s, dtype=torch.bfloat16) * 0.1)(D, N) / N ** 0.5),
            "C_imag": _w((lambda *s: torch.randn(*s, dtype=torch.bfloat16) * 0.1)(D, N) / N ** 0.5),
            "log_dt": _w((lambda *s: torch.randn(*s, dtype=torch.bfloat16) * 0.05)(D) * 0.5 - 4.0),
            "D_skip": _w((lambda *s: torch.randn(*s, dtype=torch.bfloat16) * 0.05)(D)),
        }
    _A_in = _A_setup()

    def _B_setup():
        B, S, D = 1, 2048, 640
        ks = 4
        return {
            "q": _w((lambda *s: torch.randn(*s, dtype=torch.bfloat16) * 0.05)(B, S, D)),
            "k": _w((lambda *s: torch.randn(*s, dtype=torch.bfloat16) * 0.2)(B, S, D)),
            "v": _w((lambda *s: torch.randn(*s, dtype=torch.bfloat16) * 0.2)(B, S, D)),
            "shift_k": _w((lambda *s: torch.randn(*s, dtype=torch.bfloat16) * 0.2)(D, ks) * 0.5),
            "ssm_k": _w((lambda *s: torch.randn(*s, dtype=torch.bfloat16) * 0.8)(D, S) * (1.0 / S ** 0.5)),
            "ssm_D": _w((lambda *s: torch.randn(*s, dtype=torch.bfloat16) * 0.2)(D)),
        }
    _B_in = _B_setup()

    return {
        "A_u": _A_in["u"],
        "A_log_A_real": _A_in["log_A_real"],
        "A_A_imag": _A_in["A_imag"],
        "A_C_real": _A_in["C_real"],
        "A_C_imag": _A_in["C_imag"],
        "A_log_dt": _A_in["log_dt"],
        "A_D_skip": _A_in["D_skip"],
        "B_q": _B_in["q"],
        "B_k": _B_in["k"],
        "B_v": _B_in["v"],
        "B_shift_k": _B_in["shift_k"],
        "B_ssm_k": _B_in["ssm_k"],
        "B_ssm_D": _B_in["ssm_D"],
    }

def reference(A_u, A_log_A_real, A_A_imag, A_C_real, A_C_imag, A_log_dt, A_D_skip, B_q, B_k, B_v, B_shift_k, B_ssm_k, B_ssm_D):
    def _A_ref(u, log_A_real, A_imag, C_real, C_imag, log_dt, D_skip):
        L = u.shape[1]
        dt = torch.exp(log_dt)
        A = -torch.exp(log_A_real) + 1j * A_imag
        C = (C_real + 1j * C_imag) * dt[:, None]
        pos = (lambda x, dt: x.to(dt))(torch.arange(L), log_dt.dtype)
        P = torch.exp((A * dt[:, None])[:, :, None] * pos[None, None, :])
        K = 2.0 * torch.einsum("dn,dnl->dl", C, P).real
        L2 = 2 * L
        u_t = (lambda x, *d: x.permute(*d))(u, 0, 2, 1)
        Kf = (lambda x, *a, **k: torch.fft.rfft(x.float(), *a, **k))(K, L2)
        Uf = (lambda x, *a, **k: torch.fft.rfft(x.float(), *a, **k))(u_t, L2)
        y = (lambda x, *a, **k: torch.fft.irfft(x, *a, **k).to(torch.bfloat16))(Uf * Kf[None, :, :], L2)[:, :, :L]
        y = (lambda x, *d: x.permute(*d))(y, 0, 2, 1)
        return y + u * D_skip[None, None, :]

    def _B_ref(q, k, v, shift_k, ssm_k, ssm_D):
        B, S, D = q.shape
        ks = shift_k.shape[-1]
        k_pad = _pad(k, ((0, 0), (ks - 1, 0), (0, 0)))
        k_shift = torch.zeros_like(k)
        for t in range(ks):
            k_shift = k_shift + k_pad[:, t:t + S, :] * shift_k[:, ks - 1 - t][None, None, :]
        kv = k_shift * v
        L = 2 * S
        kv_pad = _pad(kv, ((0, 0), (0, S), (0, 0)))
        kf_pad = _pad(ssm_k, ((0, 0), (0, S)))
        kv_f = (lambda x, axes=(-2,-1): torch.fft.rfft2(x.float(), dim=axes))(kv_pad[:, None, :, :], axes=(1, 2))
        kf_f = (lambda x, axes=(-2,-1): torch.fft.rfft2(x.float(), dim=axes))(kf_pad[:, None, :], axes=(1, 2))
        kf_f = (lambda x, *d: x.permute(*d))(kf_f, 1, 2, 0)
        y_f = kv_f * kf_f[None, :, :, :]
        y = (lambda x, s, axes=(-2,-1): torch.fft.irfft2(x, s=s, dim=axes).to(torch.bfloat16))(y_f, (1, L), axes=(1, 2))[:, 0, :S, :]
        y = y + kv * ssm_D[None, None, :]
        return q * y

    a = _A_ref(A_u, A_log_A_real, A_A_imag, A_C_real, A_C_imag, A_log_dt, A_D_skip)
    b = _B_ref(B_q, B_k, B_v, B_shift_k, B_ssm_k, B_ssm_D)
    return torch.concatenate([a, b], axis=-1)
```

```asm
; @launch grid=(256,1,1) block=(512,1,1) lds=163840
.amdgcn_target "amdgcn-amd-amdhsa--gfx950"
.text
.globl concat_heads__ssm_conv_s4d__ssm_conv_h3__prompt_kernel
.p2align 8
.type concat_heads__ssm_conv_s4d__ssm_conv_h3__prompt_kernel,@function
concat_heads__ssm_conv_s4d__ssm_conv_h3__prompt_kernel:
  s_cmp_ge_u32 s2, 256
  s_cbranch_scc1 L_EXIT
  s_cmp_ge_u32 s2, 16
  s_cbranch_scc1 L_WORK
  s_getpc_b64 s[8:9]
  s_and_b32 s8, s8, 0xffffff00
  s_and_b32 s9, s9, 0xffff
  s_mov_b32 s10, L_CODE_END-concat_heads__ssm_conv_s4d__ssm_conv_h3__prompt_kernel
  s_mov_b32 s11, 0x20000
  v_lshlrev_b32 v2, 7, v0
  buffer_load_dword v3, v2, s[8:11], 0 offen
  s_load_dwordx2 s[12:13], s[0:1], 104
  s_lshr_b32 s16, s2, 3
  s_lshl_b32 s16, s16, 9
  v_add_u32 v4, s16, v0
  v_mul_u32_u24 v4, 5120, v4
  s_waitcnt lgkmcnt(0)
  s_and_b32 s13, s13, 0xffff
  s_mov_b32 s14, 5242880
  s_mov_b32 s15, 0x20000
  buffer_load_dword v5, v4, s[12:15], 0 offen
  s_endpgm
L_WORK:
  s_sub_u32 s2, s2, 16
  v_lshrrev_b32 v1, 6, v0
  s_and_b32 s6, s2, 7
  v_readfirstlane_b32 s4, v1
  s_lshr_b32 s7, s2, 3
  s_mov_b32 s40, 0
  s_mov_b32 s41, 0x80000000
  s_mov_b32 s42, 7
  s_mov_b32 s43, 0
  s_lshr_b32 s44, s4, 2
  s_and_b32 s45, s4, 3
  s_cmp_ge_u32 s7, 10
  s_cbranch_scc1 L_A
  s_mul_i32 s3, s6, 10
  s_add_u32 s3, s3, s7
L_B:
  s_load_dwordx8 s[52:59], s[0:1], 56
  s_load_dwordx4 s[60:63], s[0:1], 88
  s_load_dwordx2 s[64:65], s[0:1], 104
  s_lshl_b32 s5, s3, 3
  v_and_b32 v1, 63, v0
  v_mov_b32 v11, 0xffff0000
  s_lshl_b32 s49, s4, 10
  v_and_b32 v32, 7, v1
  v_lshlrev_b32 v32, 2, v32
  v_bfe_u32 v33, v1, 3, 2
  v_add_u32 v32, v32, v33
  s_lshl_b32 s48, s4, 5
  v_add_u32 v32, s48, v32
  v_mul_u32_u24 v32, 1280, v32
  s_lshl_b32 s48, s5, 1
  v_add_u32 v32, s48, v32
  v_cmp_gt_u32 vcc, 32, v1
  v_lshlrev_b32 v36, 4, v1
  v_and_b32 v37, 3, v1
  v_lshlrev_b32 v37, 4, v37
  s_add_u32 s7, s5, s4
  s_waitcnt lgkmcnt(0)
  s_mov_b32 s16, s60
  s_and_b32 s17, s61, 0xffff
  s_mov_b32 s18, 2621440
  s_mov_b32 s19, 0x20000
  s_mov_b32 s20, s58
  s_and_b32 s21, s59, 0xffff
  s_mov_b32 s22, 5120
  s_mov_b32 s23, 0x20000
  s_lshl_b32 s46, s5, 3
  buffer_load_dwordx4 v[56:59], v37, s[20:23], s46 offen
  s_lshl_b32 s48, s7, 1
  s_and_b32 s46, s48, 0xfffffffc
  s_load_dword s66, s[62:63], s46
  v_mov_b32 v33, s56
  v_mov_b32 v34, s57
  v_mov_b32 v35, s54
  v_cndmask_b32 v33, v33, v35, vcc
  v_mov_b32 v35, s55
  v_cndmask_b32 v34, v34, v35, vcc
  v_add_co_u32 v12, vcc, v33, v32
  s_mov_b32 s32, 0x05040100
  s_mov_b32 s33, 0x07060302
  v_addc_co_u32 v13, vcc, 0, v34, vcc
  s_mov_b32 s34, 0x07060100
  s_add_u32 s48, s49, 73344
  s_mov_b32 m0, s48
  s_nop 0
  global_load_lds_dwordx4 v[12:13], off
  v_add_co_u32 v12, vcc, 0x50000, v12
  s_nop 1
  v_addc_co_u32 v13, vcc, 0, v13, vcc
  v_lshlrev_b32 v39, 4, v1
  s_mov_b32 s8, s52
  s_and_b32 s9, s53, 0xffff
  s_mov_b32 s10, 2621440
  s_mov_b32 s11, 0x20000
  s_mov_b32 s12, s64
  s_and_b32 s13, s65, 0xffff
  s_mov_b32 s14, 5242880
  s_mov_b32 s15, 0x20000
  v_mov_b32 v60, 0
  s_mul_i32 s67, s4, 4864
  v_lshlrev_b32 v33, 2, v1
  v_add_u32 v34, s67, v33
  s_mul_i32 s68, s4, 4176
  s_add_u32 s68, s68, 38912
  v_add_u32 v35, s68, v33
  s_mov_b64 exec, 0xfffffff
  ds_write_b32 v34, v60 offset:0
  ds_write_b32 v34, v60 offset:1216
  ds_write_b32 v34, v60 offset:2432
  ds_write_b32 v34, v60 offset:3648
  s_mov_b64 exec, 0xffff
  ds_write_b32 v35, v60
  s_mov_b64 exec, 0xf
  v_add_u32 v33, 72320, v33
  ds_write_b32 v33, v60 offset:240
  ds_write_b32 v33, v60 offset:368
  ds_write_b32 v33, v60 offset:496
  s_mov_b64 exec, -1
  v_bfe_u32 v32, v1, 4, 1
  v_lshlrev_b32 v32, 5, v32
  v_bfe_u32 v33, v1, 5, 1
  v_lshlrev_b32 v33, 6, v33
  v_sub_u32 v32, v32, v33
  v_bfe_u32 v33, v1, 2, 2
  v_lshlrev_b32 v33, 3, v33
  v_sub_u32 v32, v32, v33
  v_and_b32 v33, 3, v1
  v_lshlrev_b32 v33, 3, v33
  v_add_u32 v32, v32, v33
  v_add_u32 v32, 96, v32
  v_add_u32 v2, s68, v32
  v_and_b32 v32, 3, v1
  v_mul_u32_u24 v32, 1216, v32
  v_bfe_u32 v33, v1, 2, 3
  v_bfe_u32 v34, v1, 5, 1
  v_add_u32 v33, v33, v34
  v_lshlrev_b32 v33, 4, v33
  v_add_u32 v32, v32, v33
  v_add_u32 v3, s67, v32
  v_lshlrev_b32 v32, 2, v1
  s_mul_i32 s48, s4, 1040
  s_add_u32 s48, s48, 138880
  v_add_u32 v4, s48, v32
  s_mov_b32 s47, s48
  s_lshl_b32 s48, s45, 8
  s_add_u32 s48, s48, 138880
  v_add_u32 v5, s48, v32
  v_lshrrev_b32 v32, 2, v1
  s_lshl_b32 s48, s45, 4
  v_add_u32 v32, s48, v32
  v_lshrrev_b32 v33, 3, v32
  v_lshlrev_b32 v33, 10, v33
  v_and_b32 v34, 7, v32
  v_lshlrev_b32 v35, 4, v34
  v_add_u32 v33, v33, v35
  v_and_b32 v35, 3, v1
  v_lshlrev_b32 v36, 2, v35
  v_add_u32 v33, v33, v36
  v_add_u32 v6, 73344, v33
  v_cmp_eq_u32 vcc, 0, v34
  v_mov_b32 v36, -16
  v_mov_b32 v37, -912
  v_cndmask_b32 v36, v36, v37, vcc
  v_add_u32 v7, v6, v36
  v_mul_u32_u24 v35, 8352, v35
  v_lshlrev_b32 v32, 3, v32
  v_add_u32 v32, v32, v35
  v_add_u32 v8, 38976, v32
  s_lshl_b32 s48, s45, 6
  v_add_u32 v32, s48, v1
  v_mul_u32_u24 v33, 1280, v32
  s_lshl_b32 s48, s5, 1
  v_add_u32 v9, s48, v33
  v_lshlrev_b32 v33, 1, v33
  s_add_u32 s48, s48, 1280
  v_add_u32 v10, s48, v33
  v_lshlrev_b32 v38, 2, v1
  v_add_u32 v38, s67, v38
  s_waitcnt vmcnt(0)
  s_waitcnt lgkmcnt(0)
  v_lshlrev_b32 v14, 16, v56
  v_and_b32 v15, v11, v56
  v_lshlrev_b32 v16, 16, v57
  v_and_b32 v17, v11, v57
  v_lshlrev_b32 v18, 16, v58
  v_and_b32 v19, v11, v58
  v_lshlrev_b32 v20, 16, v59
  v_and_b32 v21, v11, v59
  s_lshl_b32 s46, s7, 12
  buffer_load_dwordx4 v[96:99], v39, s[16:19], s46 offen offset:0
  buffer_load_dwordx4 v[100:103], v39, s[16:19], s46 offen offset:1024
  buffer_load_dwordx4 v[104:107], v39, s[16:19], s46 offen offset:2048
  buffer_load_dwordx4 v[108:111], v39, s[16:19], s46 offen offset:3072
  s_barrier
  s_cmp_eq_u32 s44, 0
  s_cbranch_scc0 L_B_s0y
  ds_read_b32 v48, v7 offset:128
  ds_read_b32 v49, v7 offset:256
  ds_read_b32 v50, v7 offset:384
  ds_read_b32 v51, v6 offset:0
  ds_read_b32 v52, v6 offset:128
  ds_read_b32 v53, v6 offset:256
  ds_read_b32 v54, v6 offset:384
  ds_read_b32 v55, v6 offset:512
  ds_read_b32 v56, v6 offset:640
  ds_read_b32 v57, v6 offset:768
  ds_read_b32 v58, v6 offset:896
  s_waitcnt lgkmcnt(10)
  v_lshlrev_b32 v28, 16, v48
  v_mul_f32 v59, v28, v17
  s_waitcnt lgkmcnt(9)
  v_lshlrev_b32 v28, 16, v49
  v_fmac_f32 v59, v28, v16
  v_mul_f32 v61, v28, v17
  s_waitcnt lgkmcnt(8)
  v_lshlrev_b32 v28, 16, v50
  v_fmac_f32 v59, v28, v15
  v_fmac_f32 v61, v28, v16
  v_mul_f32 v63, v28, v17
  s_waitcnt lgkmcnt(7)
  v_lshlrev_b32 v28, 16, v51
  v_fmac_f32 v59, v28, v14
  v_fmac_f32 v61, v28, v15
  v_fmac_f32 v63, v28, v16
  v_mul_f32 v1, v28, v17
  s_waitcnt lgkmcnt(6)
  v_lshlrev_b32 v28, 16, v52
  v_fmac_f32 v61, v28, v14
  v_fmac_f32 v63, v28, v15
  v_fmac_f32 v1, v28, v16
  s_waitcnt lgkmcnt(5)
  v_lshlrev_b32 v28, 16, v53
  v_fmac_f32 v63, v28, v14
  v_fmac_f32 v1, v28, v15
  s_waitcnt lgkmcnt(4)
  v_lshlrev_b32 v28, 16, v54
  v_fmac_f32 v1, v28, v14
  s_waitcnt lgkmcnt(3)
  v_lshlrev_b32 v48, 16, v55
  s_waitcnt lgkmcnt(2)
  v_lshlrev_b32 v49, 16, v56
  s_waitcnt lgkmcnt(1)
  v_lshlrev_b32 v50, 16, v57
  s_waitcnt lgkmcnt(0)
  v_lshlrev_b32 v51, 16, v58
  v_mul_f32 v59, v59, v48
  v_mul_f32 v61, v61, v49
  v_mul_f32 v63, v63, v50
  v_mul_f32 v1, v1, v51
  v_cvt_pk_bf16_f32 v48, v59, v61
  v_cvt_pk_bf16_f32 v49, v63, v1
  ds_write_b64 v8, v[48:49] offset:0
  s_branch L_B_s0e
L_B_s0y:
  ds_read_b32 v48, v7 offset:128
  ds_read_b32 v49, v7 offset:256
  ds_read_b32 v50, v7 offset:384
  ds_read_b32 v51, v6 offset:0
  ds_read_b32 v52, v6 offset:128
  ds_read_b32 v53, v6 offset:256
  ds_read_b32 v54, v6 offset:384
  ds_read_b32 v55, v6 offset:512
  ds_read_b32 v56, v6 offset:640
  ds_read_b32 v57, v6 offset:768
  ds_read_b32 v58, v6 offset:896
  s_waitcnt lgkmcnt(10)
  v_and_b32 v29, v11, v48
  v_mul_f32 v60, v29, v21
  s_waitcnt lgkmcnt(9)
  v_and_b32 v29, v11, v49
  v_fmac_f32 v60, v29, v20
  v_mul_f32 v62, v29, v21
  s_waitcnt lgkmcnt(8)
  v_and_b32 v29, v11, v50
  v_fmac_f32 v60, v29, v19
  v_fmac_f32 v62, v29, v20
  v_mul_f32 v0, v29, v21
  s_waitcnt lgkmcnt(7)
  v_and_b32 v29, v11, v51
  v_fmac_f32 v60, v29, v18
  v_fmac_f32 v62, v29, v19
  v_fmac_f32 v0, v29, v20
  v_mul_f32 v31, v29, v21
  s_waitcnt lgkmcnt(6)
  v_and_b32 v29, v11, v52
  v_fmac_f32 v62, v29, v18
  v_fmac_f32 v0, v29, v19
  v_fmac_f32 v31, v29, v20
  s_waitcnt lgkmcnt(5)
  v_and_b32 v29, v11, v53
  v_fmac_f32 v0, v29, v18
  v_fmac_f32 v31, v29, v19
  s_waitcnt lgkmcnt(4)
  v_and_b32 v29, v11, v54
  v_fmac_f32 v31, v29, v18
  s_waitcnt lgkmcnt(3)
  v_and_b32 v55, v11, v55
  s_waitcnt lgkmcnt(2)
  v_and_b32 v56, v11, v56
  s_waitcnt lgkmcnt(1)
  v_and_b32 v57, v11, v57
  s_waitcnt lgkmcnt(0)
  v_and_b32 v58, v11, v58
  v_mul_f32 v60, v60, v55
  v_mul_f32 v62, v62, v56
  v_mul_f32 v0, v0, v57
  v_mul_f32 v31, v31, v58
  v_cvt_pk_bf16_f32 v50, v60, v62
  v_cvt_pk_bf16_f32 v51, v0, v31
  ds_write_b64 v8, v[50:51] offset:4176
L_B_s0e:
  s_add_u32 s48, s49, 81536
  s_mov_b32 m0, s48
  s_nop 0
  global_load_lds_dwordx4 v[12:13], off
  v_add_co_u32 v12, vcc, 0x50000, v12
  s_nop 1
  v_addc_co_u32 v13, vcc, 0, v13, vcc
  s_waitcnt vmcnt(1)
  s_and_b32 s48, s7, 1
  s_lshl_b32 s48, s48, 4
  s_lshr_b32 s66, s66, s48
  s_lshl_b32 s66, s66, 16
  s_mov_b64 exec, 1
  v_lshlrev_b32 v32, 16, v96
  v_add_f32 v32, s66, v32
  v_cvt_pk_bf16_f32 v32, v32, v32
  v_perm_b32 v96, v96, v32, s34
  s_mov_b64 exec, -1
  v_perm_b32 v112, v98, v96, s32
  v_perm_b32 v113, v98, v96, s33
  v_perm_b32 v114, v99, v97, s32
  v_perm_b32 v115, v99, v97, s33
  ds_write_b32 v38, v112 offset:112
  ds_write_b32 v38, v113 offset:1328
  ds_write_b32 v38, v114 offset:2544
  ds_write_b32 v38, v115 offset:3760
  v_perm_b32 v116, v102, v100, s32
  v_perm_b32 v117, v102, v100, s33
  v_perm_b32 v118, v103, v101, s32
  v_perm_b32 v119, v103, v101, s33
  ds_write_b32 v38, v116 offset:368
  ds_write_b32 v38, v117 offset:1584
  ds_write_b32 v38, v118 offset:2800
  ds_write_b32 v38, v119 offset:4016
  v_perm_b32 v120, v106, v104, s32
  v_perm_b32 v121, v106, v104, s33
  v_perm_b32 v122, v107, v105, s32
  v_perm_b32 v123, v107, v105, s33
  ds_write_b32 v38, v120 offset:624
  ds_write_b32 v38, v121 offset:1840
  ds_write_b32 v38, v122 offset:3056
  ds_write_b32 v38, v123 offset:4272
  v_perm_b32 v124, v110, v108, s32
  v_perm_b32 v125, v110, v108, s33
  v_perm_b32 v126, v111, v109, s32
  v_perm_b32 v127, v111, v109, s33
  ds_write_b32 v38, v124 offset:880
  ds_write_b32 v38, v125 offset:2096
  ds_write_b32 v38, v126 offset:3312
  ds_write_b32 v38, v127 offset:4528
  s_waitcnt lgkmcnt(0)
  s_cmp_eq_u32 s44, 0
  s_cbranch_scc0 L_B_Y
  ds_read_b128 a[12:15], v3 offset:96
  ds_read_b128 a[28:31], v3 offset:224
  ds_read_b128 a[44:47], v3 offset:352
  ds_read_b128 a[60:63], v3 offset:480
  s_barrier
  s_add_u32 s48, s49, 89728
  s_mov_b32 m0, s48
  s_nop 0
  global_load_lds_dwordx4 v[12:13], off
  v_add_co_u32 v12, vcc, 0x50000, v12
  s_nop 1
  v_addc_co_u32 v13, vcc, 0, v13, vcc
  ds_read_b128 v[176:179], v3 offset:608
  ds_read_b128 v[180:183], v3 offset:576
  ds_read_b128 v[184:187], v3 offset:544
  ds_read_b128 v[188:191], v3 offset:512
  ds_read_b64_tr_b16 v[32:33], v2 offset:32
  ds_read_b64_tr_b16 v[34:35], v2 offset:0
  ds_read_b64_tr_b16 v[36:37], v2 offset:160
  ds_read_b64_tr_b16 v[38:39], v2 offset:128
  ds_read_b64_tr_b16 v[40:41], v2 offset:288
  ds_read_b64_tr_b16 v[42:43], v2 offset:256
  s_waitcnt lgkmcnt(4)
  v_mfma_f32_32x32x16_bf16 v[64:79], a[12:15], v[32:35], 0
  ds_read_b128 a[8:11], v3 offset:64
  v_mfma_f32_32x32x16_bf16 v[80:95], a[28:31], v[32:35], 0
  ds_read_b128 a[24:27], v3 offset:192
  v_mfma_f32_32x32x16_bf16 v[96:111], a[44:47], v[32:35], 0
  ds_read_b128 a[40:43], v3 offset:320
  v_mfma_f32_32x32x16_bf16 v[112:127], a[60:63], v[32:35], 0
  ds_read_b128 a[56:59], v3 offset:448
  ds_read_b64_tr_b16 v[44:45], v2 offset:416
  ds_read_b64_tr_b16 v[46:47], v2 offset:384
  s_waitcnt lgkmcnt(5)
  v_mfma_f32_32x32x16_bf16 v[64:79], a[8:11], v[36:39], v[64:79]
  ds_read_b128 a[4:7], v3 offset:32
  s_waitcnt lgkmcnt(5)
  v_mfma_f32_32x32x16_bf16 v[80:95], a[24:27], v[36:39], v[80:95]
  ds_read_b128 a[20:23], v3 offset:160
  s_waitcnt lgkmcnt(5)
  v_mfma_f32_32x32x16_bf16 v[96:111], a[40:43], v[36:39], v[96:111]
  ds_read_b128 a[36:39], v3 offset:288
  s_waitcnt lgkmcnt(5)
  v_mfma_f32_32x32x16_bf16 v[112:127], a[56:59], v[36:39], v[112:127]
  ds_read_b128 a[52:55], v3 offset:416
  ds_read_b64_tr_b16 v[32:33], v2 offset:32
  ds_read_b64_tr_b16 v[34:35], v2 offset:0
  ds_read_b64_tr_b16 v[36:37], v2 offset:160
  ds_read_b64_tr_b16 v[38:39], v2 offset:128
  s_waitcnt lgkmcnt(7)
  v_mfma_f32_32x32x16_bf16 v[64:79], a[4:7], v[40:43], v[64:79]
  ds_read_b128 a[0:3], v3 offset:0
  s_waitcnt lgkmcnt(7)
  v_mfma_f32_32x32x16_bf16 v[80:95], a[20:23], v[40:43], v[80:95]
  s_waitcnt vmcnt(1)
  s_barrier
  s_setprio 2
  s_add_u32 s48, s49, 97920
  s_mov_b32 m0, s48
  s_nop 0
  global_load_lds_dwordx4 v[12:13], off
  v_add_co_u32 v12, vcc, 0x50000, v12
  s_nop 1
  v_addc_co_u32 v13, vcc, 0, v13, vcc
  s_add_u32 s48, s49, 106112
  s_mov_b32 m0, s48
  s_nop 0
  global_load_lds_dwordx4 v[12:13], off
  v_add_co_u32 v12, vcc, 0x50000, v12
  s_nop 1
  v_addc_co_u32 v13, vcc, 0, v13, vcc
  ds_read_b128 a[16:19], v3 offset:128
  ds_read_b32 v48, v7 offset:8320
  ds_read_b32 v49, v7 offset:8448
  ds_read_b32 v50, v7 offset:8576
  ds_read_b32 v51, v6 offset:8192
  s_waitcnt lgkmcnt(11)
  v_mfma_f32_32x32x16_bf16 v[96:111], a[36:39], v[40:43], v[96:111]
  ds_read_b32 v52, v6 offset:8320
  ds_read_b32 v53, v6 offset:8448
  ds_read_b32 v54, v6 offset:8576
  ds_read_b32 v55, v6 offset:8704
  s_waitcnt lgkmcnt(14)
  ds_read_b32 v56, v6 offset:8832
  s_waitcnt lgkmcnt(14)
  ds_read_b32 v57, v6 offset:8960
  s_waitcnt lgkmcnt(14)
  ds_read_b32 v58, v6 offset:9088
  s_waitcnt lgkmcnt(10)
  v_lshlrev_b32 v28, 16, v48
  v_and_b32 v29, v11, v48
  ds_read_b128 a[32:35], v3 offset:256
  v_mfma_f32_32x32x16_bf16 v[112:127], a[52:55], v[40:43], v[112:127]
  v_mul_f32 v59, v28, v17
  v_mul_f32 v60, v29, v21
  s_waitcnt lgkmcnt(10)
  v_lshlrev_b32 v28, 16, v49
  v_and_b32 v29, v11, v49
  v_fmac_f32 v59, v28, v16
  v_fmac_f32 v60, v29, v20
  v_mul_f32 v61, v28, v17
  v_mul_f32 v62, v29, v21
  s_waitcnt lgkmcnt(9)
  v_lshlrev_b32 v28, 16, v50
  v_and_b32 v29, v11, v50
  v_fmac_f32 v59, v28, v15
  v_fmac_f32 v60, v29, v19
  v_fmac_f32 v61, v28, v16
  ds_read_b128 a[48:51], v3 offset:384
  ds_read_b64_tr_b16 v[40:41], v2 offset:288
  ds_read_b64_tr_b16 v[42:43], v2 offset:256
  v_mfma_f32_32x32x16_bf16 v[64:79], a[0:3], v[44:47], v[64:79]
  v_fmac_f32 v62, v29, v20
  v_mul_f32 v63, v28, v17
  v_mul_f32 v0, v29, v21
  s_waitcnt lgkmcnt(11)
  v_lshlrev_b32 v28, 16, v51
  v_and_b32 v29, v11, v51
  v_fmac_f32 v59, v28, v14
  v_fmac_f32 v60, v29, v18
  v_fmac_f32 v61, v28, v15
  v_fmac_f32 v62, v29, v19
  v_fmac_f32 v63, v28, v16
  v_fmac_f32 v0, v29, v20
  v_mul_f32 v1, v28, v17
  v_mul_f32 v31, v29, v21
  s_waitcnt lgkmcnt(10)
  v_lshlrev_b32 v28, 16, v52
  v_mfma_f32_32x32x16_bf16 v[80:95], a[16:19], v[44:47], v[80:95]
  v_and_b32 v29, v11, v52
  v_fmac_f32 v61, v28, v14
  v_fmac_f32 v62, v29, v18
  v_fmac_f32 v63, v28, v15
  v_fmac_f32 v0, v29, v19
  v_fmac_f32 v1, v28, v16
  v_fmac_f32 v31, v29, v20
  s_waitcnt lgkmcnt(9)
  v_lshlrev_b32 v28, 16, v53
  v_and_b32 v29, v11, v53
  v_fmac_f32 v63, v28, v14
  v_fmac_f32 v0, v29, v18
  v_fmac_f32 v1, v28, v15
  v_fmac_f32 v31, v29, v19
  s_waitcnt lgkmcnt(3)
  v_mfma_f32_32x32x16_bf16 v[96:111], a[32:35], v[44:47], v[96:111]
  v_lshlrev_b32 v28, 16, v54
  v_and_b32 v29, v11, v54
  v_fmac_f32 v1, v28, v14
  v_fmac_f32 v31, v29, v18
  v_lshlrev_b32 v48, 16, v55
  v_and_b32 v55, v11, v55
  v_lshlrev_b32 v49, 16, v56
  v_and_b32 v56, v11, v56
  v_lshlrev_b32 v50, 16, v57
  v_and_b32 v57, v11, v57
  v_lshlrev_b32 v51, 16, v58
  v_and_b32 v58, v11, v58
  v_mul_f32 v59, v59, v48
  s_waitcnt lgkmcnt(2)
  v_mfma_f32_32x32x16_bf16 v[112:127], a[48:51], v[44:47], v[112:127]
  v_mul_f32 v60, v60, v55
  v_mul_f32 v61, v61, v49
  v_mul_f32 v62, v62, v56
  v_mul_f32 v63, v63, v50
  v_mul_f32 v0, v0, v57
  v_mul_f32 v1, v1, v51
  v_mul_f32 v31, v31, v58
  v_cvt_pk_bf16_f32 v48, v59, v61
  v_cvt_pk_bf16_f32 v49, v63, v1
  v_cvt_pk_bf16_f32 v50, v60, v62
  v_cvt_pk_bf16_f32 v51, v0, v31
  ds_write_b64 v8, v[48:49] offset:512
  ds_write_b64 v8, v[50:51] offset:4688
  s_waitcnt vmcnt(2) lgkmcnt(0)
  s_barrier
  s_setprio 0
  s_add_u32 s48, s49, 114304
  s_mov_b32 m0, s48
  s_nop 0
  global_load_lds_dwordx4 v[12:13], off
  v_add_co_u32 v12, vcc, 0x50000, v12
  s_nop 1
  v_addc_co_u32 v13, vcc, 0, v13, vcc
  ds_read_b64_tr_b16 v[44:45], v2 offset:416
  ds_read_b64_tr_b16 v[46:47], v2 offset:384
  v_mfma_f32_32x32x16_bf16 v[128:143], v[176:179], v[32:35], 0
  v_add_f32_dpp v28, v67, v66 wave_shr:1 row_mask:0xf bank_mask:0xf bound_ctrl:0
  ds_read_b64_tr_b16 v[32:33], v2 offset:544
  ds_read_b64_tr_b16 v[34:35], v2 offset:512
  v_mfma_f32_32x32x16_bf16 v[128:143], v[180:183], v[36:39], v[128:143]
  v_add_f32_dpp v29, v67, v70 wave_ror:1 row_mask:0x1 bank_mask:0x1
  v_add_f32_dpp v29, v71, v70 wave_shr:1 row_mask:0xf bank_mask:0xf
  ds_read_b64_tr_b16 v[36:37], v2 offset:672
  ds_read_b64_tr_b16 v[38:39], v2 offset:640
  v_mfma_f32_32x32x16_bf16 v[128:143], v[184:187], v[40:43], v[128:143]
  ds_read_b64_tr_b16 v[40:41], v2 offset:800
  ds_read_b64_tr_b16 v[42:43], v2 offset:768
  s_waitcnt lgkmcnt(6)
  v_mfma_f32_32x32x16_bf16 v[128:143], v[188:191], v[44:47], v[128:143]
  v_add_f32_dpp v30, v71, v74 wave_ror:1 row_mask:0x1 bank_mask:0x1
  v_add_f32_dpp v30, v75, v74 wave_shr:1 row_mask:0xf bank_mask:0xf
  s_waitcnt lgkmcnt(4)
  v_mfma_f32_32x32x16_bf16 v[80:95], a[12:15], v[32:35], v[80:95]
  v_add_f32_dpp v26, v75, v78 wave_ror:1 row_mask:0x1 bank_mask:0x1
  v_add_f32_dpp v26, v79, v78 wave_shr:1 row_mask:0xf bank_mask:0xf
  v_mfma_f32_32x32x16_bf16 v[96:111], a[28:31], v[32:35], v[96:111]
  v_add_f32_dpp v66, v28, v65 wave_shr:1 row_mask:0xf bank_mask:0xf bound_ctrl:0
  v_mfma_f32_32x32x16_bf16 v[112:127], a[44:47], v[32:35], v[112:127]
  v_mfma_f32_32x32x16_bf16 v[128:143], a[60:63], v[32:35], v[128:143]
  v_add_f32_dpp v70, v28, v69 wave_ror:1 row_mask:0x1 bank_mask:0x1
  v_add_f32_dpp v70, v29, v69 wave_shr:1 row_mask:0xf bank_mask:0xf
  ds_read_b64_tr_b16 v[44:45], v2 offset:928
  ds_read_b64_tr_b16 v[46:47], v2 offset:896
  s_waitcnt lgkmcnt(4)
  v_mfma_f32_32x32x16_bf16 v[80:95], a[8:11], v[36:39], v[80:95]
  v_add_f32_dpp v74, v29, v73 wave_ror:1 row_mask:0x1 bank_mask:0x1
  v_add_f32_dpp v74, v30, v73 wave_shr:1 row_mask:0xf bank_mask:0xf
  v_mfma_f32_32x32x16_bf16 v[96:111], a[24:27], v[36:39], v[96:111]
  v_mfma_f32_32x32x16_bf16 v[112:127], a[40:43], v[36:39], v[112:127]
  v_add_f32_dpp v78, v30, v77 wave_ror:1 row_mask:0x1 bank_mask:0x1
  v_add_f32_dpp v78, v26, v77 wave_shr:1 row_mask:0xf bank_mask:0xf
  v_mfma_f32_32x32x16_bf16 v[128:143], a[56:59], v[36:39], v[128:143]
  v_add_f32_dpp v65, v66, v64 wave_shr:1 row_mask:0xf bank_mask:0xf bound_ctrl:0
  ds_read_b64_tr_b16 v[32:33], v2 offset:32
  ds_read_b64_tr_b16 v[34:35], v2 offset:0
  s_waitcnt lgkmcnt(4)
  v_mfma_f32_32x32x16_bf16 v[80:95], a[4:7], v[40:43], v[80:95]
  v_add_f32_dpp v69, v66, v68 wave_ror:1 row_mask:0x1 bank_mask:0x1
  v_add_f32_dpp v69, v70, v68 wave_shr:1 row_mask:0xf bank_mask:0xf
  v_mfma_f32_32x32x16_bf16 v[96:111], a[20:23], v[40:43], v[96:111]
  v_mfma_f32_32x32x16_bf16 v[112:127], a[36:39], v[40:43], v[112:127]
  v_add_f32_dpp v73, v70, v72 wave_ror:1 row_mask:0x1 bank_mask:0x1
  v_add_f32_dpp v73, v74, v72 wave_shr:1 row_mask:0xf bank_mask:0xf
  v_mfma_f32_32x32x16_bf16 v[128:143], a[52:55], v[40:43], v[128:143]
  v_add_f32_dpp v77, v74, v76 wave_ror:1 row_mask:0x1 bank_mask:0x1
  v_add_f32_dpp v77, v78, v76 wave_shr:1 row_mask:0xf bank_mask:0xf
  ds_read_b64_tr_b16 v[36:37], v2 offset:160
  ds_read_b64_tr_b16 v[38:39], v2 offset:128
  s_waitcnt lgkmcnt(4)
  v_mfma_f32_32x32x16_bf16 v[80:95], a[0:3], v[44:47], v[80:95]
  v_mfma_f32_32x32x16_bf16 v[96:111], a[16:19], v[44:47], v[96:111]
  v_mfma_f32_32x32x16_bf16 v[112:127], a[32:35], v[44:47], v[112:127]
  s_mov_b32 m0, s47
  s_nop 0
  ds_write_addtid_b32 v65 offset:0
  ds_write_addtid_b32 v69 offset:256
  ds_write_addtid_b32 v73 offset:512
  ds_write_addtid_b32 v77 offset:768
  v_mfma_f32_32x32x16_bf16 v[128:143], a[48:51], v[44:47], v[128:143]
  s_waitcnt vmcnt(2) lgkmcnt(0)
  s_barrier
  s_setprio 2
  s_add_u32 s48, s49, 122496
  s_mov_b32 m0, s48
  s_nop 0
  global_load_lds_dwordx4 v[12:13], off
  v_add_co_u32 v12, vcc, 0x50000, v12
  s_nop 1
  v_addc_co_u32 v13, vcc, 0, v13, vcc
  ds_read_b128 v[64:67], v3 offset:736
  ds_read_b128 v[68:71], v3 offset:864
  ds_read_b128 v[72:75], v3 offset:992
  ds_read_b64_tr_b16 v[40:41], v2 offset:288
  ds_read_b64_tr_b16 v[42:43], v2 offset:256
  ds_read_b64_tr_b16 v[44:45], v2 offset:416
  ds_read_b64_tr_b16 v[46:47], v2 offset:384
  s_waitcnt lgkmcnt(6)
  v_mfma_f32_32x32x16_bf16 v[144:159], v[64:67], v[32:35], 0
  ds_read_b32 v48, v7 offset:24704
  ds_read_b32 v49, v7 offset:24832
  ds_read_b32 v50, v7 offset:24960
  ds_read_b32 v51, v6 offset:24576
  ds_read_b32 v52, v6 offset:24704
  ds_read_b128 v[64:67], v3 offset:704
  s_waitcnt lgkmcnt(11)
  v_mfma_f32_32x32x16_bf16 v[160:175], v[68:71], v[32:35], 0
  ds_read_b32 v53, v6 offset:24832
  ds_read_b32 v54, v6 offset:24960
  ds_read_b32 v55, v6 offset:25088
  ds_read_b32 v56, v6 offset:25216
  s_waitcnt lgkmcnt(14)
  ds_read_b128 v[68:71], v3 offset:832
  v_mfma_f32_32x32x16_bf16 v[176:191], v[72:75], v[32:35], 0
  s_waitcnt lgkmcnt(14)
  ds_read_b32 v57, v6 offset:25344
  s_waitcnt lgkmcnt(14)
  ds_read_b32 v58, v6 offset:25472
  s_waitcnt lgkmcnt(12)
  v_lshlrev_b32 v28, 16, v48
  v_and_b32 v29, v11, v48
  v_mul_f32 v59, v28, v17
  ds_read_b128 v[72:75], v3 offset:960
  ds_read_b64_tr_b16 v[32:33], v2 offset:1056
  ds_read_b64_tr_b16 v[34:35], v2 offset:1024
  s_waitcnt lgkmcnt(10)
  v_mfma_f32_32x32x16_bf16 v[144:159], v[64:67], v[36:39], v[144:159]
  v_mul_f32 v60, v29, v21
  v_lshlrev_b32 v28, 16, v49
  v_and_b32 v29, v11, v49
  v_fmac_f32 v59, v28, v16
  ds_read_b128 v[64:67], v3 offset:672
  s_waitcnt lgkmcnt(6)
  v_mfma_f32_32x32x16_bf16 v[160:175], v[68:71], v[36:39], v[160:175]
  v_fmac_f32 v60, v29, v20
  v_mul_f32 v61, v28, v17
  v_mul_f32 v62, v29, v21
  v_lshlrev_b32 v28, 16, v50
  v_and_b32 v29, v11, v50
  ds_read_b128 v[68:71], v3 offset:800
  s_waitcnt lgkmcnt(4)
  v_mfma_f32_32x32x16_bf16 v[176:191], v[72:75], v[36:39], v[176:191]
  v_fmac_f32 v59, v28, v15
  v_fmac_f32 v60, v29, v19
  v_fmac_f32 v61, v28, v16
  v_fmac_f32 v62, v29, v20
  ds_read_b128 v[72:75], v3 offset:928
  ds_read_b64_tr_b16 v[36:37], v2 offset:1184
  ds_read_b64_tr_b16 v[38:39], v2 offset:1152
  s_waitcnt lgkmcnt(4)
  v_mfma_f32_32x32x16_bf16 v[144:159], v[64:67], v[40:43], v[144:159]
  v_mul_f32 v63, v28, v17
  v_mul_f32 v0, v29, v21
  v_lshlrev_b32 v28, 16, v51
  v_and_b32 v29, v11, v51
  v_fmac_f32 v59, v28, v14
  ds_read_b128 v[64:67], v3 offset:640
  s_waitcnt lgkmcnt(4)
  v_mfma_f32_32x32x16_bf16 v[160:175], v[68:71], v[40:43], v[160:175]
  v_fmac_f32 v60, v29, v18
  v_fmac_f32 v61, v28, v15
  v_fmac_f32 v62, v29, v19
  v_fmac_f32 v63, v28, v16
  ds_read_b128 v[68:71], v3 offset:768
  s_waitcnt lgkmcnt(4)
  v_mfma_f32_32x32x16_bf16 v[176:191], v[72:75], v[40:43], v[176:191]
  v_fmac_f32 v0, v29, v20
  v_mul_f32 v1, v28, v17
  v_mul_f32 v31, v29, v21
  v_lshlrev_b32 v28, 16, v52
  v_and_b32 v29, v11, v52
  ds_read_b128 v[72:75], v3 offset:896
  ds_read_b64_tr_b16 v[40:41], v2 offset:1312
  ds_read_b64_tr_b16 v[42:43], v2 offset:1280
  s_waitcnt lgkmcnt(4)
  v_mfma_f32_32x32x16_bf16 v[144:159], v[64:67], v[44:47], v[144:159]
  v_fmac_f32 v61, v28, v14
  v_fmac_f32 v62, v29, v18
  v_fmac_f32 v63, v28, v15
  v_fmac_f32 v0, v29, v19
  ds_read_b128 v[64:67], v3 offset:608
  s_waitcnt lgkmcnt(4)
  v_mfma_f32_32x32x16_bf16 v[160:175], v[68:71], v[44:47], v[160:175]
  v_fmac_f32 v1, v28, v16
  v_fmac_f32 v31, v29, v20
  v_lshlrev_b32 v28, 16, v53
  v_and_b32 v29, v11, v53
  v_fmac_f32 v63, v28, v14
  ds_read_b128 v[68:71], v3 offset:736
  s_waitcnt lgkmcnt(4)
  v_mfma_f32_32x32x16_bf16 v[176:191], v[72:75], v[44:47], v[176:191]
  v_fmac_f32 v0, v29, v18
  v_fmac_f32 v1, v28, v15
  v_fmac_f32 v31, v29, v19
  v_lshlrev_b32 v28, 16, v54
  v_and_b32 v29, v11, v54
  ds_read_b128 v[72:75], v3 offset:864
  ds_read_b64_tr_b16 v[44:45], v2 offset:1440
  ds_read_b64_tr_b16 v[46:47], v2 offset:1408
  v_mfma_f32_32x32x16_bf16 v[96:111], a[12:15], v[32:35], v[96:111]
  v_fmac_f32 v1, v28, v14
  v_fmac_f32 v31, v29, v18
  v_lshlrev_b32 v48, 16, v55
  v_and_b32 v55, v11, v55
  v_mfma_f32_32x32x16_bf16 v[112:127], a[28:31], v[32:35], v[112:127]
  v_lshlrev_b32 v49, 16, v56
  v_and_b32 v56, v11, v56
  v_lshlrev_b32 v50, 16, v57
  v_and_b32 v57, v11, v57
  v_lshlrev_b32 v51, 16, v58
  v_mfma_f32_32x32x16_bf16 v[128:143], a[44:47], v[32:35], v[128:143]
  v_and_b32 v58, v11, v58
  v_mul_f32 v59, v59, v48
  v_mul_f32 v60, v60, v55
  v_mul_f32 v61, v61, v49
  ds_read_b64_tr_b16 v[32:33], v2 offset:544
  ds_read_b64_tr_b16 v[34:35], v2 offset:512
  v_mfma_f32_32x32x16_bf16 v[96:111], a[8:11], v[36:39], v[96:111]
  v_mul_f32 v62, v62, v56
  v_mul_f32 v63, v63, v50
  v_mul_f32 v0, v0, v57
  v_mul_f32 v1, v1, v51
  v_mul_f32 v31, v31, v58
  v_mfma_f32_32x32x16_bf16 v[112:127], a[24:27], v[36:39], v[112:127]
  v_cvt_pk_bf16_f32 v48, v59, v61
  v_cvt_pk_bf16_f32 v49, v63, v1
  v_cvt_pk_bf16_f32 v50, v60, v62
  v_cvt_pk_bf16_f32 v51, v0, v31
  v_mfma_f32_32x32x16_bf16 v[128:143], a[40:43], v[36:39], v[128:143]
  ds_write_b64 v8, v[48:49] offset:1536
  ds_write_b64 v8, v[50:51] offset:5712
  v_add_f32_dpp v28, v79, v82 wave_ror:1 row_mask:0x1 bank_mask:0x1
  v_add_f32_dpp v28, v83, v82 wave_shr:1 row_mask:0xf bank_mask:0xf
  ds_read_b64_tr_b16 v[36:37], v2 offset:672
  ds_read_b64_tr_b16 v[38:39], v2 offset:640
  s_waitcnt lgkmcnt(11)
  v_mfma_f32_32x32x16_bf16 v[96:111], a[4:7], v[40:43], v[96:111]
  v_add_f32_dpp v29, v83, v86 wave_ror:1 row_mask:0x1 bank_mask:0x1
  v_add_f32_dpp v29, v87, v86 wave_shr:1 row_mask:0xf bank_mask:0xf
  v_add_f32_dpp v30, v87, v90 wave_ror:1 row_mask:0x1 bank_mask:0x1
  v_add_f32_dpp v30, v91, v90 wave_shr:1 row_mask:0xf bank_mask:0xf
  v_add_f32_dpp v27, v91, v94 wave_ror:1 row_mask:0x1 bank_mask:0x1
  v_add_f32_dpp v27, v95, v94 wave_shr:1 row_mask:0xf bank_mask:0xf
  v_mfma_f32_32x32x16_bf16 v[112:127], a[20:23], v[40:43], v[112:127]
  v_add_f32_dpp v82, v26, v81 wave_ror:1 row_mask:0x1 bank_mask:0x1
  v_add_f32_dpp v82, v28, v81 wave_shr:1 row_mask:0xf bank_mask:0xf
  v_add_f32_dpp v86, v28, v85 wave_ror:1 row_mask:0x1 bank_mask:0x1
  v_add_f32_dpp v86, v29, v85 wave_shr:1 row_mask:0xf bank_mask:0xf
  v_mfma_f32_32x32x16_bf16 v[128:143], a[36:39], v[40:43], v[128:143]
  v_add_f32_dpp v90, v29, v89 wave_ror:1 row_mask:0x1 bank_mask:0x1
  v_add_f32_dpp v90, v30, v89 wave_shr:1 row_mask:0xf bank_mask:0xf
  v_add_f32_dpp v94, v30, v93 wave_ror:1 row_mask:0x1 bank_mask:0x1
  v_add_f32_dpp v94, v27, v93 wave_shr:1 row_mask:0xf bank_mask:0xf
  ds_read_b64_tr_b16 v[40:41], v2 offset:800
  ds_read_b64_tr_b16 v[42:43], v2 offset:768
  s_waitcnt lgkmcnt(8)
  v_mfma_f32_32x32x16_bf16 v[96:111], a[0:3], v[44:47], v[96:111]
  v_add_f32_dpp v81, v78, v80 wave_ror:1 row_mask:0x1 bank_mask:0x1
  v_add_f32_dpp v81, v82, v80 wave_shr:1 row_mask:0xf bank_mask:0xf
  v_add_f32_dpp v85, v82, v84 wave_ror:1 row_mask:0x1 bank_mask:0x1
  v_add_f32_dpp v85, v86, v84 wave_shr:1 row_mask:0xf bank_mask:0xf
  v_mfma_f32_32x32x16_bf16 v[112:127], a[16:19], v[44:47], v[112:127]
  v_add_f32_dpp v89, v86, v88 wave_ror:1 row_mask:0x1 bank_mask:0x1
  v_add_f32_dpp v89, v90, v88 wave_shr:1 row_mask:0xf bank_mask:0xf
  v_add_f32_dpp v93, v90, v92 wave_ror:1 row_mask:0x1 bank_mask:0x1
  v_add_f32_dpp v93, v94, v92 wave_shr:1 row_mask:0xf bank_mask:0xf
  v_mfma_f32_32x32x16_bf16 v[128:143], a[32:35], v[44:47], v[128:143]
  s_mov_b32 m0, s47
  s_nop 0
  ds_write_addtid_b32 v81 offset:8320
  ds_write_addtid_b32 v85 offset:8576
  ds_write_addtid_b32 v89 offset:8832
  ds_write_addtid_b32 v93 offset:9088
  s_mov_b32 s46, 327680
  buffer_load_dwordx4 v[22:25], v9, s[8:11], s46 offen
  s_waitcnt vmcnt(3) lgkmcnt(0)
  s_barrier
  s_setprio 0
  s_add_u32 s48, s49, 130688
  s_mov_b32 m0, s48
  s_nop 0
  global_load_lds_dwordx4 v[12:13], off
  v_add_co_u32 v12, vcc, 0x50000, v12
  s_nop 1
  v_addc_co_u32 v13, vcc, 0, v13, vcc
  ds_read_b128 v[80:83], v3 offset:576
  ds_read_b128 v[84:87], v3 offset:704
  ds_read_b128 v[88:91], v3 offset:832
  ds_read_b64_tr_b16 v[44:45], v2 offset:928
  ds_read_b64_tr_b16 v[46:47], v2 offset:896
  v_mfma_f32_32x32x16_bf16 v[144:159], v[64:67], v[32:35], v[144:159]
  v_add_f32_dpp v28, v95, v98 wave_ror:1 row_mask:0x1 bank_mask:0x1
  v_add_f32_dpp v28, v99, v98 wave_shr:1 row_mask:0xf bank_mask:0xf
  ds_read_b128 v[64:67], v3 offset:544
  v_mfma_f32_32x32x16_bf16 v[160:175], v[68:71], v[32:35], v[160:175]
  v_add_f32_dpp v29, v99, v102 wave_ror:1 row_mask:0x1 bank_mask:0x1
  v_add_f32_dpp v29, v103, v102 wave_shr:1 row_mask:0xf bank_mask:0xf
  v_add_f32_dpp v30, v103, v106 wave_ror:1 row_mask:0x1 bank_mask:0x1
  v_add_f32_dpp v30, v107, v106 wave_shr:1 row_mask:0xf bank_mask:0xf
  ds_read_b128 v[68:71], v3 offset:672
  v_mfma_f32_32x32x16_bf16 v[176:191], v[72:75], v[32:35], v[176:191]
  v_add_f32_dpp v26, v107, v110 wave_ror:1 row_mask:0x1 bank_mask:0x1
  v_add_f32_dpp v26, v111, v110 wave_shr:1 row_mask:0xf bank_mask:0xf
  ds_read_b128 v[72:75], v3 offset:800
  ds_read_b64_tr_b16 v[32:33], v2 offset:1568
  ds_read_b64_tr_b16 v[34:35], v2 offset:1536
  s_waitcnt lgkmcnt(9)
  v_mfma_f32_32x32x16_bf16 v[144:159], v[80:83], v[36:39], v[144:159]
  v_add_f32_dpp v98, v27, v97 wave_ror:1 row_mask:0x1 bank_mask:0x1
  v_add_f32_dpp v98, v28, v97 wave_shr:1 row_mask:0xf bank_mask:0xf
  v_add_f32_dpp v102, v28, v101 wave_ror:1 row_mask:0x1 bank_mask:0x1
  v_add_f32_dpp v102, v29, v101 wave_shr:1 row_mask:0xf bank_mask:0xf
  ds_read_b128 v[80:83], v3 offset:512
  s_waitcnt lgkmcnt(9)
  v_mfma_f32_32x32x16_bf16 v[160:175], v[84:87], v[36:39], v[160:175]
  v_add_f32_dpp v106, v29, v105 wave_ror:1 row_mask:0x1 bank_mask:0x1
  v_add_f32_dpp v106, v30, v105 wave_shr:1 row_mask:0xf bank_mask:0xf
  ds_read_b128 v[84:87], v3 offset:640
  s_waitcnt lgkmcnt(9)
  v_mfma_f32_32x32x16_bf16 v[176:191], v[88:91], v[36:39], v[176:191]
  v_add_f32_dpp v110, v30, v109 wave_ror:1 row_mask:0x1 bank_mask:0x1
  v_add_f32_dpp v110, v26, v109 wave_shr:1 row_mask:0xf bank_mask:0xf
  v_add_f32_dpp v97, v94, v96 wave_ror:1 row_mask:0x1 bank_mask:0x1
  v_add_f32_dpp v97, v98, v96 wave_shr:1 row_mask:0xf bank_mask:0xf
  ds_read_b128 v[88:91], v3 offset:768
  ds_read_b64_tr_b16 v[36:37], v2 offset:1696
  ds_read_b64_tr_b16 v[38:39], v2 offset:1664
  s_waitcnt lgkmcnt(9)
  v_mfma_f32_32x32x16_bf16 v[144:159], v[64:67], v[40:43], v[144:159]
  v_add_f32_dpp v101, v98, v100 wave_ror:1 row_mask:0x1 bank_mask:0x1
  v_add_f32_dpp v101, v102, v100 wave_shr:1 row_mask:0xf bank_mask:0xf
  ds_read_b128 v[64:67], v3 offset:608
  s_waitcnt lgkmcnt(9)
  v_mfma_f32_32x32x16_bf16 v[160:175], v[68:71], v[40:43], v[160:175]
  v_add_f32_dpp v105, v102, v104 wave_ror:1 row_mask:0x1 bank_mask:0x1
  v_add_f32_dpp v105, v106, v104 wave_shr:1 row_mask:0xf bank_mask:0xf
  v_add_f32_dpp v109, v106, v108 wave_ror:1 row_mask:0x1 bank_mask:0x1
  v_add_f32_dpp v109, v110, v108 wave_shr:1 row_mask:0xf bank_mask:0xf
  ds_read_b128 v[68:71], v3 offset:736
  s_waitcnt lgkmcnt(9)
  v_mfma_f32_32x32x16_bf16 v[176:191], v[72:75], v[40:43], v[176:191]
  s_mov_b32 m0, s47
  s_nop 0
  ds_write_addtid_b32 v97 offset:16640
  ds_write_addtid_b32 v101 offset:16896
  ds_write_addtid_b32 v105 offset:17152
  ds_write_addtid_b32 v109 offset:17408
  ds_read_b128 v[72:75], v3 offset:576
  ds_read_b64_tr_b16 v[40:41], v2 offset:1824
  s_waitcnt lgkmcnt(14)
  ds_read_b64_tr_b16 v[42:43], v2 offset:1792
  s_waitcnt lgkmcnt(13)
  v_mfma_f32_32x32x16_bf16 v[144:159], v[80:83], v[44:47], v[144:159]
  ds_read_b32 v48, v5 offset:8320
  ds_read_b128 v[80:83], v3 offset:704
  s_waitcnt lgkmcnt(14)
  v_mfma_f32_32x32x16_bf16 v[160:175], v[84:87], v[44:47], v[160:175]
  ds_read_b32 v49, v5 offset:9360
  s_waitcnt lgkmcnt(14)
  ds_read_b32 v50, v5 offset:10400
  s_waitcnt lgkmcnt(14)
  ds_read_b32 v51, v5 offset:11440
  s_waitcnt lgkmcnt(14)
  ds_read_b128 v[84:87], v3 offset:544
  v_mfma_f32_32x32x16_bf16 v[176:191], v[88:91], v[44:47], v[176:191]
  s_waitcnt lgkmcnt(14)
  ds_read_b32 v52, v5 offset:12480
  s_waitcnt lgkmcnt(14)
  ds_read_b32 v53, v5 offset:13520
  s_waitcnt lgkmcnt(14)
  ds_read_b32 v54, v5 offset:14560
  s_waitcnt lgkmcnt(14)
  ds_read_b128 v[88:91], v3 offset:672
  s_waitcnt lgkmcnt(14)
  ds_read_b64_tr_b16 v[44:45], v2 offset:1952
  s_waitcnt lgkmcnt(14)
  ds_read_b64_tr_b16 v[46:47], v2 offset:1920
  v_mfma_f32_32x32x16_bf16 v[112:127], a[12:15], v[32:35], v[112:127]
  s_waitcnt lgkmcnt(14)
  ds_read_b32 v55, v5 offset:15600
  s_waitcnt vmcnt(1)
  v_lshlrev_b32 v56, 16, v22
  v_and_b32 v57, v11, v22
  v_mfma_f32_32x32x16_bf16 v[128:143], a[28:31], v[32:35], v[128:143]
  s_waitcnt lgkmcnt(12)
  v_mul_f32 v48, v48, v56
  s_waitcnt lgkmcnt(10)
  v_mul_f32 v49, v49, v57
  v_cvt_pk_bf16_f32 v58, v48, v49
  ds_read_b64_tr_b16 v[32:33], v2 offset:1056
  ds_read_b64_tr_b16 v[34:35], v2 offset:1024
  v_mfma_f32_32x32x16_bf16 v[112:127], a[8:11], v[36:39], v[112:127]
  v_lshlrev_b32 v56, 16, v23
  v_and_b32 v57, v11, v23
  s_waitcnt lgkmcnt(11)
  v_mul_f32 v50, v50, v56
  v_mfma_f32_32x32x16_bf16 v[128:143], a[24:27], v[36:39], v[128:143]
  s_waitcnt lgkmcnt(10)
  v_mul_f32 v51, v51, v57
  v_cvt_pk_bf16_f32 v59, v50, v51
  ds_read_b64_tr_b16 v[36:37], v2 offset:1184
  ds_read_b64_tr_b16 v[38:39], v2 offset:1152
  v_mfma_f32_32x32x16_bf16 v[112:127], a[4:7], v[40:43], v[112:127]
  v_lshlrev_b32 v56, 16, v24
  v_and_b32 v57, v11, v24
  s_waitcnt lgkmcnt(10)
  v_mul_f32 v52, v52, v56
  v_mfma_f32_32x32x16_bf16 v[128:143], a[20:23], v[40:43], v[128:143]
  s_waitcnt lgkmcnt(9)
  v_mul_f32 v53, v53, v57
  v_cvt_pk_bf16_f32 v60, v52, v53
  v_lshlrev_b32 v56, 16, v25
  ds_read_b64_tr_b16 v[40:41], v2 offset:1312
  ds_read_b64_tr_b16 v[42:43], v2 offset:1280
  s_waitcnt lgkmcnt(7)
  v_mfma_f32_32x32x16_bf16 v[112:127], a[0:3], v[44:47], v[112:127]
  v_and_b32 v57, v11, v25
  v_mul_f32 v54, v54, v56
  s_waitcnt lgkmcnt(6)
  v_mul_f32 v55, v55, v57
  v_mfma_f32_32x32x16_bf16 v[128:143], a[16:19], v[44:47], v[128:143]
  v_cvt_pk_bf16_f32 v61, v54, v55
  s_mov_b32 s46, 655360
  buffer_store_dwordx4 v[58:61], v10, s[12:15], s46 offen
  s_nop 1
  s_barrier
  s_setprio 2
  ds_read_b64_tr_b16 v[44:45], v2 offset:1440
  ds_read_b64_tr_b16 v[46:47], v2 offset:1408
  s_waitcnt lgkmcnt(6)
  v_mfma_f32_32x32x16_bf16 v[144:159], a[60:63], v[32:35], v[144:159]
  ds_read_b32 v48, v7 offset:41088
  ds_read_b32 v49, v7 offset:41216
  ds_read_b32 v50, v7 offset:41344
  ds_read_b32 v51, v6 offset:40960
  ds_read_b32 v52, v6 offset:41088
  v_mfma_f32_32x32x16_bf16 v[160:175], v[64:67], v[32:35], v[160:175]
  ds_read_b32 v53, v6 offset:41216
  ds_read_b32 v54, v6 offset:41344
  ds_read_b32 v55, v6 offset:41472
  ds_read_b32 v56, v6 offset:41600
  s_waitcnt lgkmcnt(14)
  ds_read_b128 v[64:67], v3 offset:512
  v_mfma_f32_32x32x16_bf16 v[176:191], v[68:71], v[32:35], v[176:191]
  s_waitcnt lgkmcnt(14)
  ds_read_b32 v57, v6 offset:41728
  s_waitcnt lgkmcnt(14)
  ds_read_b32 v58, v6 offset:41856
  s_waitcnt lgkmcnt(11)
  v_lshlrev_b32 v28, 16, v48
  v_and_b32 v29, v11, v48
  v_mul_f32 v59, v28, v17
  ds_read_b128 v[68:71], v3 offset:640
  ds_read_b64_tr_b16 v[32:33], v2 offset:1568
  ds_read_b64_tr_b16 v[34:35], v2 offset:1536
  v_mfma_f32_32x32x16_bf16 v[144:159], a[56:59], v[36:39], v[144:159]
  v_mul_f32 v60, v29, v21
  s_waitcnt lgkmcnt(13)
  v_lshlrev_b32 v28, 16, v49
  v_and_b32 v29, v11, v49
  v_fmac_f32 v59, v28, v16
  v_mfma_f32_32x32x16_bf16 v[160:175], v[72:75], v[36:39], v[160:175]
  v_fmac_f32 v60, v29, v20
  v_mul_f32 v61, v28, v17
  v_mul_f32 v62, v29, v21
  s_waitcnt lgkmcnt(12)
  v_lshlrev_b32 v28, 16, v50
  v_and_b32 v29, v11, v50
  v_mfma_f32_32x32x16_bf16 v[176:191], v[80:83], v[36:39], v[176:191]
  v_fmac_f32 v59, v28, v15
  v_fmac_f32 v60, v29, v19
  v_fmac_f32 v61, v28, v16
  v_fmac_f32 v62, v29, v20
  ds_read_b64_tr_b16 v[36:37], v2 offset:1696
  ds_read_b64_tr_b16 v[38:39], v2 offset:1664
  v_mfma_f32_32x32x16_bf16 v[144:159], a[52:55], v[40:43], v[144:159]
  v_mul_f32 v63, v28, v17
  v_mul_f32 v0, v29, v21
  s_waitcnt lgkmcnt(13)
  v_lshlrev_b32 v28, 16, v51
  v_and_b32 v29, v11, v51
  v_fmac_f32 v59, v28, v14
  v_mfma_f32_32x32x16_bf16 v[160:175], v[84:87], v[40:43], v[160:175]
  v_fmac_f32 v60, v29, v18
  v_fmac_f32 v61, v28, v15
  v_fmac_f32 v62, v29, v19
  v_fmac_f32 v63, v28, v16
  v_mfma_f32_32x32x16_bf16 v[176:191], v[88:91], v[40:43], v[176:191]
  v_fmac_f32 v0, v29, v20
  v_mul_f32 v1, v28, v17
  v_mul_f32 v31, v29, v21
  s_waitcnt lgkmcnt(12)
  v_lshlrev_b32 v28, 16, v52
  v_and_b32 v29, v11, v52
  ds_read_b64_tr_b16 v[40:41], v2 offset:1824
  ds_read_b64_tr_b16 v[42:43], v2 offset:1792
  v_mfma_f32_32x32x16_bf16 v[144:159], a[48:51], v[44:47], v[144:159]
  v_fmac_f32 v61, v28, v14
  v_fmac_f32 v62, v29, v18
  v_fmac_f32 v63, v28, v15
  v_fmac_f32 v0, v29, v19
  s_waitcnt lgkmcnt(9)
  v_mfma_f32_32x32x16_bf16 v[160:175], v[64:67], v[44:47], v[160:175]
  v_fmac_f32 v1, v28, v16
  v_fmac_f32 v31, v29, v20
  v_lshlrev_b32 v28, 16, v53
  v_and_b32 v29, v11, v53
  v_fmac_f32 v63, v28, v14
  s_waitcnt lgkmcnt(6)
  v_mfma_f32_32x32x16_bf16 v[176:191], v[68:71], v[44:47], v[176:191]
  v_fmac_f32 v0, v29, v18
  v_fmac_f32 v1, v28, v15
  v_fmac_f32 v31, v29, v19
  v_lshlrev_b32 v28, 16, v54
  v_and_b32 v29, v11, v54
  ds_read_b64_tr_b16 v[44:45], v2 offset:1952
  ds_read_b64_tr_b16 v[46:47], v2 offset:1920
  s_waitcnt lgkmcnt(6)
  v_mfma_f32_32x32x16_bf16 v[144:159], a[44:47], v[32:35], v[144:159]
  v_fmac_f32 v1, v28, v14
  v_fmac_f32 v31, v29, v18
  v_lshlrev_b32 v48, 16, v55
  v_and_b32 v55, v11, v55
  v_mfma_f32_32x32x16_bf16 v[160:175], a[60:63], v[32:35], v[160:175]
  v_lshlrev_b32 v49, 16, v56
  v_and_b32 v56, v11, v56
  v_lshlrev_b32 v50, 16, v57
  v_and_b32 v57, v11, v57
  v_lshlrev_b32 v51, 16, v58
  ds_read_b64_tr_b16 v[32:33], v2 offset:2080
  ds_read_b64_tr_b16 v[34:35], v2 offset:2048
  s_waitcnt lgkmcnt(6)
  v_mfma_f32_32x32x16_bf16 v[144:159], a[40:43], v[36:39], v[144:159]
  v_and_b32 v58, v11, v58
  v_mul_f32 v59, v59, v48
  v_mul_f32 v60, v60, v55
  v_mul_f32 v61, v61, v49
  v_mfma_f32_32x32x16_bf16 v[160:175], a[56:59], v[36:39], v[160:175]
  v_mul_f32 v62, v62, v56
  v_mul_f32 v63, v63, v50
  v_mul_f32 v0, v0, v57
  v_mul_f32 v1, v1, v51
  v_mul_f32 v31, v31, v58
  ds_read_b64_tr_b16 v[36:37], v2 offset:2208
  ds_read_b64_tr_b16 v[38:39], v2 offset:2176
  s_waitcnt lgkmcnt(6)
  v_mfma_f32_32x32x16_bf16 v[144:159], a[36:39], v[40:43], v[144:159]
  v_cvt_pk_bf16_f32 v48, v59, v61
  v_cvt_pk_bf16_f32 v49, v63, v1
  v_cvt_pk_bf16_f32 v50, v60, v62
  v_cvt_pk_bf16_f32 v51, v0, v31
  v_mfma_f32_32x32x16_bf16 v[160:175], a[52:55], v[40:43], v[160:175]
  ds_write_b64 v8, v[48:49] offset:2560
  ds_write_b64 v8, v[50:51] offset:6736
  v_add_f32_dpp v28, v111, v114 wave_ror:1 row_mask:0x1 bank_mask:0x1
  v_add_f32_dpp v28, v115, v114 wave_shr:1 row_mask:0xf bank_mask:0xf
  ds_read_b64_tr_b16 v[40:41], v2 offset:2336
  ds_read_b64_tr_b16 v[42:43], v2 offset:2304
  s_waitcnt lgkmcnt(8)
  v_mfma_f32_32x32x16_bf16 v[144:159], a[32:35], v[44:47], v[144:159]
  v_add_f32_dpp v29, v115, v118 wave_ror:1 row_mask:0x1 bank_mask:0x1
  v_add_f32_dpp v29, v119, v118 wave_shr:1 row_mask:0xf bank_mask:0xf
  v_add_f32_dpp v30, v119, v122 wave_ror:1 row_mask:0x1 bank_mask:0x1
  v_add_f32_dpp v30, v123, v122 wave_shr:1 row_mask:0xf bank_mask:0xf
  v_add_f32_dpp v27, v123, v126 wave_ror:1 row_mask:0x1 bank_mask:0x1
  v_add_f32_dpp v27, v127, v126 wave_shr:1 row_mask:0xf bank_mask:0xf
  v_mfma_f32_32x32x16_bf16 v[160:175], a[48:51], v[44:47], v[160:175]
  v_add_f32_dpp v114, v26, v113 wave_ror:1 row_mask:0x1 bank_mask:0x1
  v_add_f32_dpp v114, v28, v113 wave_shr:1 row_mask:0xf bank_mask:0xf
  v_add_f32_dpp v118, v28, v117 wave_ror:1 row_mask:0x1 bank_mask:0x1
  v_add_f32_dpp v118, v29, v117 wave_shr:1 row_mask:0xf bank_mask:0xf
  ds_read_b64_tr_b16 v[44:45], v2 offset:2464
  ds_read_b64_tr_b16 v[46:47], v2 offset:2432
  s_waitcnt lgkmcnt(8)
  v_mfma_f32_32x32x16_bf16 v[128:143], a[12:15], v[32:35], v[128:143]
  v_add_f32_dpp v122, v29, v121 wave_ror:1 row_mask:0x1 bank_mask:0x1
  v_add_f32_dpp v122, v30, v121 wave_shr:1 row_mask:0xf bank_mask:0xf
  v_add_f32_dpp v126, v30, v125 wave_ror:1 row_mask:0x1 bank_mask:0x1
  v_add_f32_dpp v126, v27, v125 wave_shr:1 row_mask:0xf bank_mask:0xf
  ds_read_b64_tr_b16 v[32:33], v2 offset:2080
  ds_read_b64_tr_b16 v[34:35], v2 offset:2048
  s_waitcnt lgkmcnt(8)
  v_mfma_f32_32x32x16_bf16 v[128:143], a[8:11], v[36:39], v[128:143]
  v_add_f32_dpp v113, v110, v112 wave_ror:1 row_mask:0x1 bank_mask:0x1
  v_add_f32_dpp v113, v114, v112 wave_shr:1 row_mask:0xf bank_mask:0xf
  v_add_f32_dpp v117, v114, v116 wave_ror:1 row_mask:0x1 bank_mask:0x1
  v_add_f32_dpp v117, v118, v116 wave_shr:1 row_mask:0xf bank_mask:0xf
  ds_read_b64_tr_b16 v[36:37], v2 offset:2208
  ds_read_b64_tr_b16 v[38:39], v2 offset:2176
  s_waitcnt lgkmcnt(6)
  v_mfma_f32_32x32x16_bf16 v[128:143], a[4:7], v[40:43], v[128:143]
  v_add_f32_dpp v121, v118, v120 wave_ror:1 row_mask:0x1 bank_mask:0x1
  v_add_f32_dpp v121, v122, v120 wave_shr:1 row_mask:0xf bank_mask:0xf
  v_add_f32_dpp v125, v122, v124 wave_ror:1 row_mask:0x1 bank_mask:0x1
  v_add_f32_dpp v125, v126, v124 wave_shr:1 row_mask:0xf bank_mask:0xf
  ds_read_b64_tr_b16 v[40:41], v2 offset:2336
  ds_read_b64_tr_b16 v[42:43], v2 offset:2304
  s_waitcnt lgkmcnt(6)
  v_mfma_f32_32x32x16_bf16 v[128:143], a[0:3], v[44:47], v[128:143]
  s_mov_b32 m0, s47
  s_nop 0
  ds_write_addtid_b32 v113 offset:0
  ds_write_addtid_b32 v117 offset:256
  ds_write_addtid_b32 v121 offset:512
  ds_write_addtid_b32 v125 offset:768
  s_mov_b32 s46, 983040
  buffer_load_dwordx4 v[22:25], v9, s[8:11], s46 offen
  s_waitcnt lgkmcnt(0)
  s_barrier
  s_setprio 0
  ds_read_b128 v[72:75], v3 offset:608
  ds_read_b128 v[80:83], v3 offset:576
  ds_read_b128 v[84:87], v3 offset:544
  ds_read_b128 v[88:91], v3 offset:512
  ds_read_b64_tr_b16 v[44:45], v2 offset:2464
  ds_read_b64_tr_b16 v[46:47], v2 offset:2432
  v_mfma_f32_32x32x16_bf16 v[144:159], a[28:31], v[32:35], v[144:159]
  v_add_f32_dpp v28, v127, v130 wave_ror:1 row_mask:0x1 bank_mask:0x1
  v_add_f32_dpp v28, v131, v130 wave_shr:1 row_mask:0xf bank_mask:0xf
  v_mfma_f32_32x32x16_bf16 v[160:175], a[44:47], v[32:35], v[160:175]
  v_add_f32_dpp v29, v131, v134 wave_ror:1 row_mask:0x1 bank_mask:0x1
  v_add_f32_dpp v29, v135, v134 wave_shr:1 row_mask:0xf bank_mask:0xf
  v_add_f32_dpp v30, v135, v138 wave_ror:1 row_mask:0x1 bank_mask:0x1
  v_add_f32_dpp v30, v139, v138 wave_shr:1 row_mask:0xf bank_mask:0xf
  v_mfma_f32_32x32x16_bf16 v[176:191], a[60:63], v[32:35], v[176:191]
  v_add_f32_dpp v26, v139, v142 wave_ror:1 row_mask:0x1 bank_mask:0x1
  v_add_f32_dpp v26, v143, v142 wave_shr:1 row_mask:0xf bank_mask:0xf
  ds_read_b64_tr_b16 v[32:33], v2 offset:2592
  ds_read_b64_tr_b16 v[34:35], v2 offset:2560
  v_mfma_f32_32x32x16_bf16 v[144:159], a[24:27], v[36:39], v[144:159]
  v_add_f32_dpp v130, v27, v129 wave_ror:1 row_mask:0x1 bank_mask:0x1
  v_add_f32_dpp v130, v28, v129 wave_shr:1 row_mask:0xf bank_mask:0xf
  v_add_f32_dpp v134, v28, v133 wave_ror:1 row_mask:0x1 bank_mask:0x1
  v_add_f32_dpp v134, v29, v133 wave_shr:1 row_mask:0xf bank_mask:0xf
  v_mfma_f32_32x32x16_bf16 v[160:175], a[40:43], v[36:39], v[160:175]
  v_add_f32_dpp v138, v29, v137 wave_ror:1 row_mask:0x1 bank_mask:0x1
  v_add_f32_dpp v138, v30, v137 wave_shr:1 row_mask:0xf bank_mask:0xf
  v_mfma_f32_32x32x16_bf16 v[176:191], a[56:59], v[36:39], v[176:191]
  v_add_f32_dpp v142, v30, v141 wave_ror:1 row_mask:0x1 bank_mask:0x1
  v_add_f32_dpp v142, v26, v141 wave_shr:1 row_mask:0xf bank_mask:0xf
  v_add_f32_dpp v129, v126, v128 wave_ror:1 row_mask:0x1 bank_mask:0x1
  v_add_f32_dpp v129, v130, v128 wave_shr:1 row_mask:0xf bank_mask:0xf
  ds_read_b64_tr_b16 v[36:37], v2 offset:2720
  ds_read_b64_tr_b16 v[38:39], v2 offset:2688
  v_mfma_f32_32x32x16_bf16 v[144:159], a[20:23], v[40:43], v[144:159]
  v_add_f32_dpp v133, v130, v132 wave_ror:1 row_mask:0x1 bank_mask:0x1
  v_add_f32_dpp v133, v134, v132 wave_shr:1 row_mask:0xf bank_mask:0xf
  v_mfma_f32_32x32x16_bf16 v[160:175], a[36:39], v[40:43], v[160:175]
  v_add_f32_dpp v137, v134, v136 wave_ror:1 row_mask:0x1 bank_mask:0x1
  v_add_f32_dpp v137, v138, v136 wave_shr:1 row_mask:0xf bank_mask:0xf
  v_add_f32_dpp v141, v138, v140 wave_ror:1 row_mask:0x1 bank_mask:0x1
  v_add_f32_dpp v141, v142, v140 wave_shr:1 row_mask:0xf bank_mask:0xf
  v_mfma_f32_32x32x16_bf16 v[176:191], a[52:55], v[40:43], v[176:191]
  s_mov_b32 m0, s47
  s_nop 0
  ds_write_addtid_b32 v129 offset:8320
  ds_write_addtid_b32 v133 offset:8576
  ds_write_addtid_b32 v137 offset:8832
  ds_write_addtid_b32 v141 offset:9088
  ds_read_b64_tr_b16 v[40:41], v2 offset:2848
  s_waitcnt lgkmcnt(14)
  ds_read_b64_tr_b16 v[42:43], v2 offset:2816
  s_waitcnt lgkmcnt(10)
  v_mfma_f32_32x32x16_bf16 v[144:159], a[16:19], v[44:47], v[144:159]
  ds_read_b32 v48, v5 offset:0
  v_mfma_f32_32x32x16_bf16 v[160:175], a[32:35], v[44:47], v[160:175]
  ds_read_b32 v49, v5 offset:1040
  ds_read_b32 v50, v5 offset:2080
  ds_read_b32 v51, v5 offset:3120
  v_mfma_f32_32x32x16_bf16 v[176:191], a[48:51], v[44:47], v[176:191]
  ds_read_b32 v52, v5 offset:4160
  s_waitcnt lgkmcnt(14)
  ds_read_b32 v53, v5 offset:5200
  s_waitcnt lgkmcnt(14)
  ds_read_b32 v54, v5 offset:6240
  s_waitcnt lgkmcnt(14)
  ds_read_b64_tr_b16 v[44:45], v2 offset:2976
  s_waitcnt lgkmcnt(14)
  ds_read_b64_tr_b16 v[46:47], v2 offset:2944
  v_mfma_f32_32x32x16_bf16 v[144:159], a[12:15], v[32:35], v[144:159]
  s_waitcnt lgkmcnt(14)
  ds_read_b32 v55, v5 offset:7280
  s_waitcnt vmcnt(0)
  v_lshlrev_b32 v56, 16, v22
  v_and_b32 v57, v11, v22
  v_mfma_f32_32x32x16_bf16 v[160:175], a[28:31], v[32:35], v[160:175]
  s_waitcnt lgkmcnt(9)
  v_mul_f32 v48, v48, v56
  s_waitcnt lgkmcnt(8)
  v_mul_f32 v49, v49, v57
  v_cvt_pk_bf16_f32 v58, v48, v49
  ds_read_b64_tr_b16 v[32:33], v2 offset:1568
  ds_read_b64_tr_b16 v[34:35], v2 offset:1536
  v_mfma_f32_32x32x16_bf16 v[144:159], a[8:11], v[36:39], v[144:159]
  v_lshlrev_b32 v56, 16, v23
  v_and_b32 v57, v11, v23
  s_waitcnt lgkmcnt(9)
  v_mul_f32 v50, v50, v56
  v_mfma_f32_32x32x16_bf16 v[160:175], a[24:27], v[36:39], v[160:175]
  s_waitcnt lgkmcnt(8)
  v_mul_f32 v51, v51, v57
  v_cvt_pk_bf16_f32 v59, v50, v51
  ds_read_b64_tr_b16 v[36:37], v2 offset:1696
  ds_read_b64_tr_b16 v[38:39], v2 offset:1664
  v_mfma_f32_32x32x16_bf16 v[144:159], a[4:7], v[40:43], v[144:159]
  v_lshlrev_b32 v56, 16, v24
  v_and_b32 v57, v11, v24
  s_waitcnt lgkmcnt(9)
  v_mul_f32 v52, v52, v56
  v_mfma_f32_32x32x16_bf16 v[160:175], a[20:23], v[40:43], v[160:175]
  s_waitcnt lgkmcnt(8)
  v_mul_f32 v53, v53, v57
  v_cvt_pk_bf16_f32 v60, v52, v53
  v_lshlrev_b32 v56, 16, v25
  ds_read_b64_tr_b16 v[40:41], v2 offset:1824
  ds_read_b64_tr_b16 v[42:43], v2 offset:1792
  s_waitcnt lgkmcnt(7)
  v_mfma_f32_32x32x16_bf16 v[144:159], a[0:3], v[44:47], v[144:159]
  v_and_b32 v57, v11, v25
  v_mul_f32 v54, v54, v56
  s_waitcnt lgkmcnt(6)
  v_mul_f32 v55, v55, v57
  v_mfma_f32_32x32x16_bf16 v[160:175], a[16:19], v[44:47], v[160:175]
  v_cvt_pk_bf16_f32 v61, v54, v55
  s_mov_b32 s46, 1966080
  buffer_store_dwordx4 v[58:61], v10, s[12:15], s46 offen
  s_nop 1
  s_barrier
  s_setprio 2
  ds_read_b64_tr_b16 v[44:45], v2 offset:1952
  ds_read_b64_tr_b16 v[46:47], v2 offset:1920
  s_waitcnt lgkmcnt(6)
  v_mfma_f32_32x32x16_bf16 v[176:191], v[72:75], v[32:35], v[176:191]
  ds_read_b32 v48, v7 offset:57472
  ds_read_b32 v49, v7 offset:57600
  ds_read_b32 v50, v7 offset:57728
  ds_read_b32 v51, v6 offset:57344
  ds_read_b32 v52, v6 offset:57472
  ds_read_b32 v53, v6 offset:57600
  ds_read_b32 v54, v6 offset:57728
  ds_read_b32 v55, v6 offset:57856
  ds_read_b32 v56, v6 offset:57984
  s_waitcnt lgkmcnt(14)
  ds_read_b64_tr_b16 v[32:33], v2 offset:3104
  s_waitcnt lgkmcnt(14)
  ds_read_b64_tr_b16 v[34:35], v2 offset:3072
  v_mfma_f32_32x32x16_bf16 v[176:191], v[80:83], v[36:39], v[176:191]
  s_waitcnt lgkmcnt(14)
  ds_read_b32 v57, v6 offset:58112
  s_waitcnt lgkmcnt(14)
  ds_read_b32 v58, v6 offset:58240
  s_waitcnt lgkmcnt(12)
  v_lshlrev_b32 v28, 16, v48
  v_and_b32 v29, v11, v48
  v_mul_f32 v59, v28, v17
  v_mul_f32 v60, v29, v21
  s_waitcnt lgkmcnt(11)
  v_lshlrev_b32 v28, 16, v49
  v_and_b32 v29, v11, v49
  v_fmac_f32 v59, v28, v16
  ds_read_b64_tr_b16 v[36:37], v2 offset:3232
  ds_read_b64_tr_b16 v[38:39], v2 offset:3200
  v_mfma_f32_32x32x16_bf16 v[176:191], v[84:87], v[40:43], v[176:191]
  v_fmac_f32 v60, v29, v20
  v_mul_f32 v61, v28, v17
  v_mul_f32 v62, v29, v21
  s_waitcnt lgkmcnt(12)
  v_lshlrev_b32 v28, 16, v50
  v_and_b32 v29, v11, v50
  v_fmac_f32 v59, v28, v15
  v_fmac_f32 v60, v29, v19
  v_fmac_f32 v61, v28, v16
  v_fmac_f32 v62, v29, v20
  ds_read_b64_tr_b16 v[40:41], v2 offset:3360
  ds_read_b64_tr_b16 v[42:43], v2 offset:3328
  v_mfma_f32_32x32x16_bf16 v[176:191], v[88:91], v[44:47], v[176:191]
  v_mul_f32 v63, v28, v17
  v_mul_f32 v0, v29, v21
  s_waitcnt lgkmcnt(13)
  v_lshlrev_b32 v28, 16, v51
  v_and_b32 v29, v11, v51
  v_fmac_f32 v59, v28, v14
  v_fmac_f32 v60, v29, v18
  v_fmac_f32 v61, v28, v15
  v_fmac_f32 v62, v29, v19
  v_fmac_f32 v63, v28, v16
  ds_read_b64_tr_b16 v[44:45], v2 offset:3488
  ds_read_b64_tr_b16 v[46:47], v2 offset:3456
  s_waitcnt lgkmcnt(8)
  v_mfma_f32_32x32x16_bf16 v[160:175], a[12:15], v[32:35], v[160:175]
  v_fmac_f32 v0, v29, v20
  v_mul_f32 v1, v28, v17
  v_mul_f32 v31, v29, v21
  v_lshlrev_b32 v28, 16, v52
  v_and_b32 v29, v11, v52
  v_fmac_f32 v61, v28, v14
  v_fmac_f32 v62, v29, v18
  v_fmac_f32 v63, v28, v15
  v_fmac_f32 v0, v29, v19
  v_mfma_f32_32x32x16_bf16 v[176:191], a[28:31], v[32:35], v[176:191]
  v_fmac_f32 v1, v28, v16
  v_fmac_f32 v31, v29, v20
  v_lshlrev_b32 v28, 16, v53
  v_and_b32 v29, v11, v53
  v_fmac_f32 v63, v28, v14
  v_fmac_f32 v0, v29, v18
  v_fmac_f32 v1, v28, v15
  v_fmac_f32 v31, v29, v19
  v_lshlrev_b32 v28, 16, v54
  v_and_b32 v29, v11, v54
  ds_read_b64_tr_b16 v[32:33], v2 offset:2592
  ds_read_b64_tr_b16 v[34:35], v2 offset:2560
  s_waitcnt lgkmcnt(6)
  v_mfma_f32_32x32x16_bf16 v[160:175], a[8:11], v[36:39], v[160:175]
  v_fmac_f32 v1, v28, v14
  v_fmac_f32 v31, v29, v18
  v_lshlrev_b32 v48, 16, v55
  v_and_b32 v55, v11, v55
  v_lshlrev_b32 v49, 16, v56
  v_and_b32 v56, v11, v56
  v_lshlrev_b32 v50, 16, v57
  v_and_b32 v57, v11, v57
  v_lshlrev_b32 v51, 16, v58
  v_mfma_f32_32x32x16_bf16 v[176:191], a[24:27], v[36:39], v[176:191]
  v_and_b32 v58, v11, v58
  v_mul_f32 v59, v59, v48
  v_mul_f32 v60, v60, v55
  v_mul_f32 v61, v61, v49
  v_mul_f32 v62, v62, v56
  v_mul_f32 v63, v63, v50
  v_mul_f32 v0, v0, v57
  v_mul_f32 v1, v1, v51
  v_mul_f32 v31, v31, v58
  ds_read_b64_tr_b16 v[36:37], v2 offset:2720
  ds_read_b64_tr_b16 v[38:39], v2 offset:2688
  s_waitcnt lgkmcnt(6)
  v_mfma_f32_32x32x16_bf16 v[160:175], a[4:7], v[40:43], v[160:175]
  v_cvt_pk_bf16_f32 v48, v59, v61
  v_cvt_pk_bf16_f32 v49, v63, v1
  v_cvt_pk_bf16_f32 v50, v60, v62
  v_cvt_pk_bf16_f32 v51, v0, v31
  ds_write_b64 v8, v[48:49] offset:3584
  ds_write_b64 v8, v[50:51] offset:7760
  v_add_f32_dpp v28, v143, v146 wave_ror:1 row_mask:0x1 bank_mask:0x1
  v_add_f32_dpp v28, v147, v146 wave_shr:1 row_mask:0xf bank_mask:0xf
  v_mfma_f32_32x32x16_bf16 v[176:191], a[20:23], v[40:43], v[176:191]
  v_add_f32_dpp v29, v147, v150 wave_ror:1 row_mask:0x1 bank_mask:0x1
  v_add_f32_dpp v29, v151, v150 wave_shr:1 row_mask:0xf bank_mask:0xf
  v_add_f32_dpp v30, v151, v154 wave_ror:1 row_mask:0x1 bank_mask:0x1
  v_add_f32_dpp v30, v155, v154 wave_shr:1 row_mask:0xf bank_mask:0xf
  v_add_f32_dpp v27, v155, v158 wave_ror:1 row_mask:0x1 bank_mask:0x1
  v_add_f32_dpp v27, v159, v158 wave_shr:1 row_mask:0xf bank_mask:0xf
  v_add_f32_dpp v146, v26, v145 wave_ror:1 row_mask:0x1 bank_mask:0x1
  v_add_f32_dpp v146, v28, v145 wave_shr:1 row_mask:0xf bank_mask:0xf
  v_add_f32_dpp v150, v28, v149 wave_ror:1 row_mask:0x1 bank_mask:0x1
  v_add_f32_dpp v150, v29, v149 wave_shr:1 row_mask:0xf bank_mask:0xf
  ds_read_b64_tr_b16 v[40:41], v2 offset:2848
  ds_read_b64_tr_b16 v[42:43], v2 offset:2816
  s_waitcnt lgkmcnt(8)
  v_mfma_f32_32x32x16_bf16 v[160:175], a[0:3], v[44:47], v[160:175]
  v_add_f32_dpp v154, v29, v153 wave_ror:1 row_mask:0x1 bank_mask:0x1
  v_add_f32_dpp v154, v30, v153 wave_shr:1 row_mask:0xf bank_mask:0xf
  v_add_f32_dpp v158, v30, v157 wave_ror:1 row_mask:0x1 bank_mask:0x1
  v_add_f32_dpp v158, v27, v157 wave_shr:1 row_mask:0xf bank_mask:0xf
  v_add_f32_dpp v145, v142, v144 wave_ror:1 row_mask:0x1 bank_mask:0x1
  v_add_f32_dpp v145, v146, v144 wave_shr:1 row_mask:0xf bank_mask:0xf
  v_add_f32_dpp v149, v146, v148 wave_ror:1 row_mask:0x1 bank_mask:0x1
  v_add_f32_dpp v149, v150, v148 wave_shr:1 row_mask:0xf bank_mask:0xf
  v_mfma_f32_32x32x16_bf16 v[176:191], a[16:19], v[44:47], v[176:191]
  v_add_f32_dpp v153, v150, v152 wave_ror:1 row_mask:0x1 bank_mask:0x1
  v_add_f32_dpp v153, v154, v152 wave_shr:1 row_mask:0xf bank_mask:0xf
  v_add_f32_dpp v157, v154, v156 wave_ror:1 row_mask:0x1 bank_mask:0x1
  v_add_f32_dpp v157, v158, v156 wave_shr:1 row_mask:0xf bank_mask:0xf
  s_mov_b32 m0, s47
  s_nop 0
  ds_write_addtid_b32 v145 offset:16640
  ds_write_addtid_b32 v149 offset:16896
  ds_write_addtid_b32 v153 offset:17152
  ds_write_addtid_b32 v157 offset:17408
  s_mov_b32 s46, 1638400
  buffer_load_dwordx4 v[22:25], v9, s[8:11], s46 offen
  s_waitcnt lgkmcnt(0)
  s_barrier
  s_setprio 2
  ds_read_b64_tr_b16 v[44:45], v2 offset:2976
  ds_read_b64_tr_b16 v[46:47], v2 offset:2944
  v_mfma_f32_32x32x16_bf16 v[176:191], a[44:47], v[32:35], v[176:191]
  v_add_f32_dpp v28, v159, v162 wave_ror:1 row_mask:0x1 bank_mask:0x1
  v_add_f32_dpp v28, v163, v162 wave_shr:1 row_mask:0xf bank_mask:0xf
  v_add_f32_dpp v29, v163, v166 wave_ror:1 row_mask:0x1 bank_mask:0x1
  v_add_f32_dpp v29, v167, v166 wave_shr:1 row_mask:0xf bank_mask:0xf
  v_add_f32_dpp v30, v167, v170 wave_ror:1 row_mask:0x1 bank_mask:0x1
  v_add_f32_dpp v30, v171, v170 wave_shr:1 row_mask:0xf bank_mask:0xf
  v_add_f32_dpp v26, v171, v174 wave_ror:1 row_mask:0x1 bank_mask:0x1
  v_add_f32_dpp v26, v175, v174 wave_shr:1 row_mask:0xf bank_mask:0xf
  v_add_f32_dpp v162, v27, v161 wave_ror:1 row_mask:0x1 bank_mask:0x1
  v_add_f32_dpp v162, v28, v161 wave_shr:1 row_mask:0xf bank_mask:0xf
  v_add_f32_dpp v166, v28, v165 wave_ror:1 row_mask:0x1 bank_mask:0x1
  v_add_f32_dpp v166, v29, v165 wave_shr:1 row_mask:0xf bank_mask:0xf
  ds_read_b64_tr_b16 v[32:33], v2 offset:3616
  ds_read_b64_tr_b16 v[34:35], v2 offset:3584
  v_mfma_f32_32x32x16_bf16 v[176:191], a[40:43], v[36:39], v[176:191]
  v_add_f32_dpp v170, v29, v169 wave_ror:1 row_mask:0x1 bank_mask:0x1
  v_add_f32_dpp v170, v30, v169 wave_shr:1 row_mask:0xf bank_mask:0xf
  v_add_f32_dpp v174, v30, v173 wave_ror:1 row_mask:0x1 bank_mask:0x1
  v_add_f32_dpp v174, v26, v173 wave_shr:1 row_mask:0xf bank_mask:0xf
  v_add_f32_dpp v161, v158, v160 wave_ror:1 row_mask:0x1 bank_mask:0x1
  v_add_f32_dpp v161, v162, v160 wave_shr:1 row_mask:0xf bank_mask:0xf
  v_add_f32_dpp v165, v162, v164 wave_ror:1 row_mask:0x1 bank_mask:0x1
  v_add_f32_dpp v165, v166, v164 wave_shr:1 row_mask:0xf bank_mask:0xf
  v_add_f32_dpp v169, v166, v168 wave_ror:1 row_mask:0x1 bank_mask:0x1
  v_add_f32_dpp v169, v170, v168 wave_shr:1 row_mask:0xf bank_mask:0xf
  ds_read_b64_tr_b16 v[36:37], v2 offset:3744
  ds_read_b64_tr_b16 v[38:39], v2 offset:3712
  v_mfma_f32_32x32x16_bf16 v[176:191], a[36:39], v[40:43], v[176:191]
  v_add_f32_dpp v173, v170, v172 wave_ror:1 row_mask:0x1 bank_mask:0x1
  v_add_f32_dpp v173, v174, v172 wave_shr:1 row_mask:0xf bank_mask:0xf
  s_mov_b32 m0, s47
  s_nop 0
  ds_write_addtid_b32 v161 offset:0
  ds_write_addtid_b32 v165 offset:256
  ds_write_addtid_b32 v169 offset:512
  ds_write_addtid_b32 v173 offset:768
  ds_read_b32 v48, v5 offset:16640
  ds_read_b32 v49, v5 offset:17680
  ds_read_b32 v50, v5 offset:18720
  ds_read_b32 v51, v5 offset:19760
  ds_read_b32 v52, v5 offset:20800
  s_waitcnt lgkmcnt(14)
  ds_read_b64_tr_b16 v[40:41], v2 offset:3872
  s_waitcnt lgkmcnt(14)
  ds_read_b64_tr_b16 v[42:43], v2 offset:3840
  v_mfma_f32_32x32x16_bf16 v[176:191], a[32:35], v[44:47], v[176:191]
  s_waitcnt lgkmcnt(14)
  ds_read_b32 v53, v5 offset:21840
  s_waitcnt lgkmcnt(14)
  ds_read_b32 v54, v5 offset:22880
  s_waitcnt lgkmcnt(14)
  ds_read_b32 v55, v5 offset:23920
  s_waitcnt vmcnt(0)
  v_lshlrev_b32 v56, 16, v22
  v_and_b32 v57, v11, v22
  s_waitcnt lgkmcnt(9)
  v_mul_f32 v48, v48, v56
  s_waitcnt lgkmcnt(8)
  v_mul_f32 v49, v49, v57
  v_cvt_pk_bf16_f32 v58, v48, v49
  v_lshlrev_b32 v56, 16, v23
  v_and_b32 v57, v11, v23
  s_waitcnt lgkmcnt(7)
  v_mul_f32 v50, v50, v56
  ds_read_b64_tr_b16 v[44:45], v2 offset:4000
  ds_read_b64_tr_b16 v[46:47], v2 offset:3968
  v_mfma_f32_32x32x16_bf16 v[176:191], a[12:15], v[32:35], v[176:191]
  s_waitcnt lgkmcnt(8)
  v_mul_f32 v51, v51, v57
  v_cvt_pk_bf16_f32 v59, v50, v51
  v_lshlrev_b32 v56, 16, v24
  v_and_b32 v57, v11, v24
  s_waitcnt lgkmcnt(7)
  v_mul_f32 v52, v52, v56
  s_waitcnt lgkmcnt(4)
  v_mul_f32 v53, v53, v57
  v_cvt_pk_bf16_f32 v60, v52, v53
  v_lshlrev_b32 v56, 16, v25
  v_and_b32 v57, v11, v25
  s_waitcnt lgkmcnt(3)
  v_mul_f32 v54, v54, v56
  s_waitcnt lgkmcnt(2)
  v_mul_f32 v55, v55, v57
  v_mfma_f32_32x32x16_bf16 v[176:191], a[8:11], v[36:39], v[176:191]
  v_cvt_pk_bf16_f32 v61, v54, v55
  s_mov_b32 s46, 3276800
  buffer_store_dwordx4 v[58:61], v10, s[12:15], s46 offen
  s_nop 1
  s_mov_b32 s46, 2293760
  buffer_load_dwordx4 v[22:25], v9, s[8:11], s46 offen
  v_mfma_f32_32x32x16_bf16 v[176:191], a[4:7], v[40:43], v[176:191]
  s_waitcnt lgkmcnt(0)
  v_mfma_f32_32x32x16_bf16 v[176:191], a[0:3], v[44:47], v[176:191]
  s_nop 11
  v_add_f32_dpp v28, v175, v178 wave_ror:1 row_mask:0x1 bank_mask:0x1
  s_nop 10
  v_add_f32_dpp v28, v179, v178 wave_shr:1 row_mask:0xf bank_mask:0xf
  s_nop 9
  v_add_f32_dpp v29, v179, v182 wave_ror:1 row_mask:0x1 bank_mask:0x1
  s_nop 8
  v_add_f32_dpp v29, v183, v182 wave_shr:1 row_mask:0xf bank_mask:0xf
  s_nop 7
  v_add_f32_dpp v30, v183, v186 wave_ror:1 row_mask:0x1 bank_mask:0x1
  s_nop 6
  v_add_f32_dpp v30, v187, v186 wave_shr:1 row_mask:0xf bank_mask:0xf
  s_nop 5
  v_add_f32_dpp v27, v187, v190 wave_ror:1 row_mask:0x1 bank_mask:0x1
  s_nop 4
  v_add_f32_dpp v27, v191, v190 wave_shr:1 row_mask:0xf bank_mask:0xf
  s_nop 3
  v_add_f32_dpp v178, v26, v177 wave_ror:1 row_mask:0x1 bank_mask:0x1
  s_nop 2
  v_add_f32_dpp v178, v28, v177 wave_shr:1 row_mask:0xf bank_mask:0xf
  s_nop 1
  v_add_f32_dpp v182, v28, v181 wave_ror:1 row_mask:0x1 bank_mask:0x1
  s_nop 0
  v_add_f32_dpp v182, v29, v181 wave_shr:1 row_mask:0xf bank_mask:0xf
  v_add_f32_dpp v186, v29, v185 wave_ror:1 row_mask:0x1 bank_mask:0x1
  v_add_f32_dpp v186, v30, v185 wave_shr:1 row_mask:0xf bank_mask:0xf
  v_add_f32_dpp v190, v30, v189 wave_ror:1 row_mask:0x1 bank_mask:0x1
  v_add_f32_dpp v190, v27, v189 wave_shr:1 row_mask:0xf bank_mask:0xf
  v_add_f32_dpp v177, v174, v176 wave_ror:1 row_mask:0x1 bank_mask:0x1
  v_add_f32_dpp v177, v178, v176 wave_shr:1 row_mask:0xf bank_mask:0xf
  v_add_f32_dpp v181, v178, v180 wave_ror:1 row_mask:0x1 bank_mask:0x1
  v_add_f32_dpp v181, v182, v180 wave_shr:1 row_mask:0xf bank_mask:0xf
  v_add_f32_dpp v185, v182, v184 wave_ror:1 row_mask:0x1 bank_mask:0x1
  v_add_f32_dpp v185, v186, v184 wave_shr:1 row_mask:0xf bank_mask:0xf
  v_add_f32_dpp v189, v186, v188 wave_ror:1 row_mask:0x1 bank_mask:0x1
  v_add_f32_dpp v189, v190, v188 wave_shr:1 row_mask:0xf bank_mask:0xf
  s_mov_b32 m0, s47
  s_nop 0
  ds_write_addtid_b32 v177 offset:8320
  ds_write_addtid_b32 v181 offset:8576
  ds_write_addtid_b32 v185 offset:8832
  ds_write_addtid_b32 v189 offset:9088
  s_waitcnt lgkmcnt(0)
  s_barrier
  s_setprio 0
  ds_read_b32 v48, v5 offset:8320
  ds_read_b32 v49, v5 offset:9360
  ds_read_b32 v50, v5 offset:10400
  ds_read_b32 v51, v5 offset:11440
  ds_read_b32 v52, v5 offset:12480
  ds_read_b32 v53, v5 offset:13520
  ds_read_b32 v54, v5 offset:14560
  ds_read_b32 v55, v5 offset:15600
  s_waitcnt vmcnt(0)
  v_lshlrev_b32 v56, 16, v22
  v_and_b32 v57, v11, v22
  s_waitcnt lgkmcnt(7)
  v_mul_f32 v48, v48, v56
  s_waitcnt lgkmcnt(6)
  v_mul_f32 v49, v49, v57
  v_cvt_pk_bf16_f32 v58, v48, v49
  v_lshlrev_b32 v56, 16, v23
  v_and_b32 v57, v11, v23
  s_waitcnt lgkmcnt(5)
  v_mul_f32 v50, v50, v56
  s_waitcnt lgkmcnt(4)
  v_mul_f32 v51, v51, v57
  v_cvt_pk_bf16_f32 v59, v50, v51
  v_lshlrev_b32 v56, 16, v24
  v_and_b32 v57, v11, v24
  s_waitcnt lgkmcnt(3)
  v_mul_f32 v52, v52, v56
  s_waitcnt lgkmcnt(2)
  v_mul_f32 v53, v53, v57
  v_cvt_pk_bf16_f32 v60, v52, v53
  v_lshlrev_b32 v56, 16, v25
  v_and_b32 v57, v11, v25
  s_waitcnt lgkmcnt(1)
  v_mul_f32 v54, v54, v56
  s_waitcnt lgkmcnt(0)
  v_mul_f32 v55, v55, v57
  v_cvt_pk_bf16_f32 v61, v54, v55
  s_mov_b32 s46, 4587520
  buffer_store_dwordx4 v[58:61], v10, s[12:15], s46 offen
  s_nop 1
  s_branch L_END
L_B_Y:
  ds_read_b128 a[12:15], v3 offset:96
  ds_read_b128 a[28:31], v3 offset:224
  ds_read_b128 a[44:47], v3 offset:352
  ds_read_b128 a[60:63], v3 offset:480
  s_barrier
  ds_read_b128 v[176:179], v3 offset:608
  ds_read_b128 v[180:183], v3 offset:576
  ds_read_b128 v[184:187], v3 offset:544
  ds_read_b128 v[188:191], v3 offset:512
  ds_read_b64_tr_b16 v[32:33], v2 offset:32
  ds_read_b64_tr_b16 v[34:35], v2 offset:0
  ds_read_b64_tr_b16 v[36:37], v2 offset:160
  ds_read_b64_tr_b16 v[38:39], v2 offset:128
  ds_read_b64_tr_b16 v[40:41], v2 offset:288
  ds_read_b64_tr_b16 v[42:43], v2 offset:256
  s_waitcnt lgkmcnt(4)
  v_mfma_f32_32x32x16_bf16 v[64:79], a[12:15], v[32:35], 0
  ds_read_b128 a[8:11], v3 offset:64
  v_mfma_f32_32x32x16_bf16 v[80:95], a[28:31], v[32:35], 0
  ds_read_b128 a[24:27], v3 offset:192
  v_mfma_f32_32x32x16_bf16 v[96:111], a[44:47], v[32:35], 0
  ds_read_b128 a[40:43], v3 offset:320
  v_mfma_f32_32x32x16_bf16 v[112:127], a[60:63], v[32:35], 0
  ds_read_b128 a[56:59], v3 offset:448
  ds_read_b64_tr_b16 v[44:45], v2 offset:416
  ds_read_b64_tr_b16 v[46:47], v2 offset:384
  s_waitcnt lgkmcnt(5)
  v_mfma_f32_32x32x16_bf16 v[64:79], a[8:11], v[36:39], v[64:79]
  ds_read_b128 a[4:7], v3 offset:32
  s_waitcnt lgkmcnt(5)
  v_mfma_f32_32x32x16_bf16 v[80:95], a[24:27], v[36:39], v[80:95]
  ds_read_b128 a[20:23], v3 offset:160
  s_waitcnt lgkmcnt(5)
  v_mfma_f32_32x32x16_bf16 v[96:111], a[40:43], v[36:39], v[96:111]
  ds_read_b128 a[36:39], v3 offset:288
  s_waitcnt lgkmcnt(5)
  v_mfma_f32_32x32x16_bf16 v[112:127], a[56:59], v[36:39], v[112:127]
  ds_read_b128 a[52:55], v3 offset:416
  ds_read_b64_tr_b16 v[32:33], v2 offset:32
  ds_read_b64_tr_b16 v[34:35], v2 offset:0
  ds_read_b64_tr_b16 v[36:37], v2 offset:160
  ds_read_b64_tr_b16 v[38:39], v2 offset:128
  s_waitcnt lgkmcnt(7)
  v_mfma_f32_32x32x16_bf16 v[64:79], a[4:7], v[40:43], v[64:79]
  ds_read_b128 a[0:3], v3 offset:0
  s_waitcnt lgkmcnt(7)
  v_mfma_f32_32x32x16_bf16 v[80:95], a[20:23], v[40:43], v[80:95]
  s_add_u32 s48, s49, 89728
  s_mov_b32 m0, s48
  s_nop 0
  global_load_lds_dwordx4 v[12:13], off
  v_add_co_u32 v12, vcc, 0x50000, v12
  s_nop 1
  v_addc_co_u32 v13, vcc, 0, v13, vcc
  s_waitcnt vmcnt(1)
  s_barrier
  s_setprio 0
  ds_read_b128 a[16:19], v3 offset:128
  s_waitcnt lgkmcnt(7)
  v_mfma_f32_32x32x16_bf16 v[96:111], a[36:39], v[40:43], v[96:111]
  ds_read_b128 a[32:35], v3 offset:256
  s_waitcnt lgkmcnt(7)
  v_mfma_f32_32x32x16_bf16 v[112:127], a[52:55], v[40:43], v[112:127]
  ds_read_b128 a[48:51], v3 offset:384
  ds_read_b64_tr_b16 v[40:41], v2 offset:288
  ds_read_b64_tr_b16 v[42:43], v2 offset:256
  s_waitcnt lgkmcnt(5)
  v_mfma_f32_32x32x16_bf16 v[64:79], a[0:3], v[44:47], v[64:79]
  s_waitcnt lgkmcnt(4)
  v_mfma_f32_32x32x16_bf16 v[80:95], a[16:19], v[44:47], v[80:95]
  s_waitcnt lgkmcnt(3)
  v_mfma_f32_32x32x16_bf16 v[96:111], a[32:35], v[44:47], v[96:111]
  s_waitcnt lgkmcnt(2)
  v_mfma_f32_32x32x16_bf16 v[112:127], a[48:51], v[44:47], v[112:127]
  s_add_u32 s48, s49, 97920
  s_mov_b32 m0, s48
  s_nop 0
  global_load_lds_dwordx4 v[12:13], off
  v_add_co_u32 v12, vcc, 0x50000, v12
  s_nop 1
  v_addc_co_u32 v13, vcc, 0, v13, vcc
  s_add_u32 s48, s49, 106112
  s_mov_b32 m0, s48
  s_nop 0
  global_load_lds_dwordx4 v[12:13], off
  v_add_co_u32 v12, vcc, 0x50000, v12
  s_nop 1
  v_addc_co_u32 v13, vcc, 0, v13, vcc
  s_waitcnt vmcnt(2)
  s_barrier
  s_setprio 2
  ds_read_b64_tr_b16 v[44:45], v2 offset:416
  ds_read_b64_tr_b16 v[46:47], v2 offset:384
  v_mfma_f32_32x32x16_bf16 v[128:143], v[176:179], v[32:35], 0
  ds_read_b32 v48, v7 offset:16512
  ds_read_b32 v49, v7 offset:16640
  ds_read_b32 v50, v7 offset:16768
  ds_read_b32 v51, v6 offset:16384
  ds_read_b32 v52, v6 offset:16512
  ds_read_b64_tr_b16 v[32:33], v2 offset:544
  ds_read_b64_tr_b16 v[34:35], v2 offset:512
  v_mfma_f32_32x32x16_bf16 v[128:143], v[180:183], v[36:39], v[128:143]
  ds_read_b32 v53, v6 offset:16640
  ds_read_b32 v54, v6 offset:16768
  ds_read_b32 v55, v6 offset:16896
  ds_read_b32 v56, v6 offset:17024
  s_waitcnt lgkmcnt(14)
  ds_read_b32 v57, v6 offset:17152
  s_waitcnt lgkmcnt(14)
  ds_read_b32 v58, v6 offset:17280
  s_waitcnt lgkmcnt(14)
  ds_read_b64_tr_b16 v[36:37], v2 offset:672
  s_waitcnt lgkmcnt(14)
  ds_read_b64_tr_b16 v[38:39], v2 offset:640
  v_mfma_f32_32x32x16_bf16 v[128:143], v[184:187], v[40:43], v[128:143]
  s_waitcnt lgkmcnt(14)
  v_lshlrev_b32 v28, 16, v48
  v_and_b32 v29, v11, v48
  v_mul_f32 v59, v28, v17
  v_mul_f32 v60, v29, v21
  s_waitcnt lgkmcnt(13)
  v_lshlrev_b32 v28, 16, v49
  ds_read_b64_tr_b16 v[40:41], v2 offset:800
  ds_read_b64_tr_b16 v[42:43], v2 offset:768
  v_mfma_f32_32x32x16_bf16 v[128:143], v[188:191], v[44:47], v[128:143]
  v_and_b32 v29, v11, v49
  v_fmac_f32 v59, v28, v16
  v_fmac_f32 v60, v29, v20
  v_mul_f32 v61, v28, v17
  v_mul_f32 v62, v29, v21
  s_waitcnt lgkmcnt(10)
  v_mfma_f32_32x32x16_bf16 v[80:95], a[12:15], v[32:35], v[80:95]
  v_lshlrev_b32 v28, 16, v50
  v_and_b32 v29, v11, v50
  v_fmac_f32 v59, v28, v15
  v_fmac_f32 v60, v29, v19
  v_fmac_f32 v61, v28, v16
  v_fmac_f32 v62, v29, v20
  v_mfma_f32_32x32x16_bf16 v[96:111], a[28:31], v[32:35], v[96:111]
  v_mul_f32 v63, v28, v17
  v_mul_f32 v0, v29, v21
  v_lshlrev_b32 v28, 16, v51
  v_and_b32 v29, v11, v51
  v_fmac_f32 v59, v28, v14
  v_mfma_f32_32x32x16_bf16 v[112:127], a[44:47], v[32:35], v[112:127]
  v_fmac_f32 v60, v29, v18
  v_fmac_f32 v61, v28, v15
  v_fmac_f32 v62, v29, v19
  v_fmac_f32 v63, v28, v16
  v_fmac_f32 v0, v29, v20
  v_mfma_f32_32x32x16_bf16 v[128:143], a[60:63], v[32:35], v[128:143]
  v_mul_f32 v1, v28, v17
  v_mul_f32 v31, v29, v21
  v_lshlrev_b32 v28, 16, v52
  v_and_b32 v29, v11, v52
  v_fmac_f32 v61, v28, v14
  ds_read_b64_tr_b16 v[44:45], v2 offset:928
  ds_read_b64_tr_b16 v[46:47], v2 offset:896
  s_waitcnt lgkmcnt(4)
  v_mfma_f32_32x32x16_bf16 v[80:95], a[8:11], v[36:39], v[80:95]
  v_fmac_f32 v62, v29, v18
  v_fmac_f32 v63, v28, v15
  v_fmac_f32 v0, v29, v19
  v_fmac_f32 v1, v28, v16
  v_fmac_f32 v31, v29, v20
  v_lshlrev_b32 v28, 16, v53
  v_mfma_f32_32x32x16_bf16 v[96:111], a[24:27], v[36:39], v[96:111]
  v_and_b32 v29, v11, v53
  v_fmac_f32 v63, v28, v14
  v_fmac_f32 v0, v29, v18
  v_fmac_f32 v1, v28, v15
  v_fmac_f32 v31, v29, v19
  v_mfma_f32_32x32x16_bf16 v[112:127], a[40:43], v[36:39], v[112:127]
  v_lshlrev_b32 v28, 16, v54
  v_and_b32 v29, v11, v54
  v_fmac_f32 v1, v28, v14
  v_fmac_f32 v31, v29, v18
  v_lshlrev_b32 v48, 16, v55
  v_mfma_f32_32x32x16_bf16 v[128:143], a[56:59], v[36:39], v[128:143]
  v_and_b32 v55, v11, v55
  v_lshlrev_b32 v49, 16, v56
  v_and_b32 v56, v11, v56
  v_lshlrev_b32 v50, 16, v57
  v_and_b32 v57, v11, v57
  v_lshlrev_b32 v51, 16, v58
  ds_read_b64_tr_b16 v[32:33], v2 offset:32
  ds_read_b64_tr_b16 v[34:35], v2 offset:0
  s_waitcnt lgkmcnt(4)
  v_mfma_f32_32x32x16_bf16 v[80:95], a[4:7], v[40:43], v[80:95]
  v_and_b32 v58, v11, v58
  v_mul_f32 v59, v59, v48
  v_mul_f32 v60, v60, v55
  v_mul_f32 v61, v61, v49
  v_mul_f32 v62, v62, v56
  v_mfma_f32_32x32x16_bf16 v[96:111], a[20:23], v[40:43], v[96:111]
  v_mul_f32 v63, v63, v50
  v_mul_f32 v0, v0, v57
  v_mul_f32 v1, v1, v51
  v_mul_f32 v31, v31, v58
  v_cvt_pk_bf16_f32 v48, v59, v61
  v_mfma_f32_32x32x16_bf16 v[112:127], a[36:39], v[40:43], v[112:127]
  v_cvt_pk_bf16_f32 v49, v63, v1
  v_cvt_pk_bf16_f32 v50, v60, v62
  v_cvt_pk_bf16_f32 v51, v0, v31
  ds_write_b64 v8, v[48:49] offset:1024
  ds_write_b64 v8, v[50:51] offset:5200
  v_add_f32_dpp v28, v67, v66 wave_shr:1 row_mask:0xf bank_mask:0xf bound_ctrl:0
  v_mfma_f32_32x32x16_bf16 v[128:143], a[52:55], v[40:43], v[128:143]
  v_add_f32_dpp v29, v67, v70 wave_ror:1 row_mask:0x1 bank_mask:0x1
  v_add_f32_dpp v29, v71, v70 wave_shr:1 row_mask:0xf bank_mask:0xf
  v_add_f32_dpp v30, v71, v74 wave_ror:1 row_mask:0x1 bank_mask:0x1
  v_add_f32_dpp v30, v75, v74 wave_shr:1 row_mask:0xf bank_mask:0xf
  ds_read_b64_tr_b16 v[36:37], v2 offset:160
  ds_read_b64_tr_b16 v[38:39], v2 offset:128
  s_waitcnt lgkmcnt(6)
  v_mfma_f32_32x32x16_bf16 v[80:95], a[0:3], v[44:47], v[80:95]
  v_add_f32_dpp v26, v75, v78 wave_ror:1 row_mask:0x1 bank_mask:0x1
  v_add_f32_dpp v26, v79, v78 wave_shr:1 row_mask:0xf bank_mask:0xf
  v_add_f32_dpp v66, v28, v65 wave_shr:1 row_mask:0xf bank_mask:0xf bound_ctrl:0
  v_add_f32_dpp v70, v28, v69 wave_ror:1 row_mask:0x1 bank_mask:0x1
  v_add_f32_dpp v70, v29, v69 wave_shr:1 row_mask:0xf bank_mask:0xf
  v_add_f32_dpp v74, v29, v73 wave_ror:1 row_mask:0x1 bank_mask:0x1
  v_add_f32_dpp v74, v30, v73 wave_shr:1 row_mask:0xf bank_mask:0xf
  v_mfma_f32_32x32x16_bf16 v[96:111], a[16:19], v[44:47], v[96:111]
  v_add_f32_dpp v78, v30, v77 wave_ror:1 row_mask:0x1 bank_mask:0x1
  v_add_f32_dpp v78, v26, v77 wave_shr:1 row_mask:0xf bank_mask:0xf
  v_add_f32_dpp v65, v66, v64 wave_shr:1 row_mask:0xf bank_mask:0xf bound_ctrl:0
  v_add_f32_dpp v69, v66, v68 wave_ror:1 row_mask:0x1 bank_mask:0x1
  v_add_f32_dpp v69, v70, v68 wave_shr:1 row_mask:0xf bank_mask:0xf
  v_mfma_f32_32x32x16_bf16 v[112:127], a[32:35], v[44:47], v[112:127]
  v_add_f32_dpp v73, v70, v72 wave_ror:1 row_mask:0x1 bank_mask:0x1
  v_add_f32_dpp v73, v74, v72 wave_shr:1 row_mask:0xf bank_mask:0xf
  v_add_f32_dpp v77, v74, v76 wave_ror:1 row_mask:0x1 bank_mask:0x1
  v_add_f32_dpp v77, v78, v76 wave_shr:1 row_mask:0xf bank_mask:0xf
  v_mfma_f32_32x32x16_bf16 v[128:143], a[48:51], v[44:47], v[128:143]
  s_mov_b32 m0, s47
  s_nop 0
  ds_write_addtid_b32 v65 offset:0
  ds_write_addtid_b32 v69 offset:256
  ds_write_addtid_b32 v73 offset:512
  ds_write_addtid_b32 v77 offset:768
  s_mov_b32 s46, 0
  buffer_load_dwordx4 v[22:25], v9, s[8:11], s46 offen
  s_add_u32 s48, s49, 114304
  s_mov_b32 m0, s48
  s_nop 0
  global_load_lds_dwordx4 v[12:13], off
  v_add_co_u32 v12, vcc, 0x50000, v12
  s_nop 1
  v_addc_co_u32 v13, vcc, 0, v13, vcc
  s_waitcnt vmcnt(3) lgkmcnt(0)
  s_barrier
  s_setprio 0
  ds_read_b128 v[64:67], v3 offset:736
  ds_read_b128 v[68:71], v3 offset:864
  ds_read_b128 v[72:75], v3 offset:992
  ds_read_b64_tr_b16 v[40:41], v2 offset:288
  ds_read_b64_tr_b16 v[42:43], v2 offset:256
  ds_read_b64_tr_b16 v[44:45], v2 offset:416
  ds_read_b64_tr_b16 v[46:47], v2 offset:384
  s_waitcnt lgkmcnt(6)
  v_mfma_f32_32x32x16_bf16 v[144:159], v[64:67], v[32:35], 0
  v_add_f32_dpp v28, v79, v82 wave_ror:1 row_mask:0x1 bank_mask:0x1
  v_add_f32_dpp v28, v83, v82 wave_shr:1 row_mask:0xf bank_mask:0xf
  ds_read_b128 v[64:67], v3 offset:704
  s_waitcnt lgkmcnt(6)
  v_mfma_f32_32x32x16_bf16 v[160:175], v[68:71], v[32:35], 0
  v_add_f32_dpp v29, v83, v86 wave_ror:1 row_mask:0x1 bank_mask:0x1
  v_add_f32_dpp v29, v87, v86 wave_shr:1 row_mask:0xf bank_mask:0xf
  ds_read_b128 v[68:71], v3 offset:832
  s_waitcnt lgkmcnt(6)
  v_mfma_f32_32x32x16_bf16 v[176:191], v[72:75], v[32:35], 0
  v_add_f32_dpp v30, v87, v90 wave_ror:1 row_mask:0x1 bank_mask:0x1
  v_add_f32_dpp v30, v91, v90 wave_shr:1 row_mask:0xf bank_mask:0xf
  v_add_f32_dpp v27, v91, v94 wave_ror:1 row_mask:0x1 bank_mask:0x1
  v_add_f32_dpp v27, v95, v94 wave_shr:1 row_mask:0xf bank_mask:0xf
  ds_read_b128 v[72:75], v3 offset:960
  ds_read_b64_tr_b16 v[32:33], v2 offset:1056
  ds_read_b64_tr_b16 v[34:35], v2 offset:1024
  s_waitcnt lgkmcnt(4)
  v_mfma_f32_32x32x16_bf16 v[144:159], v[64:67], v[36:39], v[144:159]
  v_add_f32_dpp v82, v26, v81 wave_ror:1 row_mask:0x1 bank_mask:0x1
  v_add_f32_dpp v82, v28, v81 wave_shr:1 row_mask:0xf bank_mask:0xf
  ds_read_b128 v[64:67], v3 offset:672
  s_waitcnt lgkmcnt(4)
  v_mfma_f32_32x32x16_bf16 v[160:175], v[68:71], v[36:39], v[160:175]
  v_add_f32_dpp v86, v28, v85 wave_ror:1 row_mask:0x1 bank_mask:0x1
  v_add_f32_dpp v86, v29, v85 wave_shr:1 row_mask:0xf bank_mask:0xf
  ds_read_b128 v[68:71], v3 offset:800
  s_waitcnt lgkmcnt(4)
  v_mfma_f32_32x32x16_bf16 v[176:191], v[72:75], v[36:39], v[176:191]
  v_add_f32_dpp v90, v29, v89 wave_ror:1 row_mask:0x1 bank_mask:0x1
  v_add_f32_dpp v90, v30, v89 wave_shr:1 row_mask:0xf bank_mask:0xf
  ds_read_b128 v[72:75], v3 offset:928
  ds_read_b64_tr_b16 v[36:37], v2 offset:1184
  ds_read_b64_tr_b16 v[38:39], v2 offset:1152
  s_waitcnt lgkmcnt(4)
  v_mfma_f32_32x32x16_bf16 v[144:159], v[64:67], v[40:43], v[144:159]
  v_add_f32_dpp v94, v30, v93 wave_ror:1 row_mask:0x1 bank_mask:0x1
  v_add_f32_dpp v94, v27, v93 wave_shr:1 row_mask:0xf bank_mask:0xf
  ds_read_b128 v[64:67], v3 offset:640
  s_waitcnt lgkmcnt(4)
  v_mfma_f32_32x32x16_bf16 v[160:175], v[68:71], v[40:43], v[160:175]
  v_add_f32_dpp v81, v78, v80 wave_ror:1 row_mask:0x1 bank_mask:0x1
  v_add_f32_dpp v81, v82, v80 wave_shr:1 row_mask:0xf bank_mask:0xf
  v_add_f32_dpp v85, v82, v84 wave_ror:1 row_mask:0x1 bank_mask:0x1
  v_add_f32_dpp v85, v86, v84 wave_shr:1 row_mask:0xf bank_mask:0xf
  ds_read_b128 v[68:71], v3 offset:768
  s_waitcnt lgkmcnt(4)
  v_mfma_f32_32x32x16_bf16 v[176:191], v[72:75], v[40:43], v[176:191]
  v_add_f32_dpp v89, v86, v88 wave_ror:1 row_mask:0x1 bank_mask:0x1
  v_add_f32_dpp v89, v90, v88 wave_shr:1 row_mask:0xf bank_mask:0xf
  ds_read_b128 v[72:75], v3 offset:896
  ds_read_b64_tr_b16 v[40:41], v2 offset:1312
  ds_read_b64_tr_b16 v[42:43], v2 offset:1280
  s_waitcnt lgkmcnt(4)
  v_mfma_f32_32x32x16_bf16 v[144:159], v[64:67], v[44:47], v[144:159]
  v_add_f32_dpp v93, v90, v92 wave_ror:1 row_mask:0x1 bank_mask:0x1
  v_add_f32_dpp v93, v94, v92 wave_shr:1 row_mask:0xf bank_mask:0xf
  ds_read_b128 v[64:67], v3 offset:608
  s_waitcnt lgkmcnt(4)
  v_mfma_f32_32x32x16_bf16 v[160:175], v[68:71], v[44:47], v[160:175]
  s_mov_b32 m0, s47
  s_nop 0
  ds_write_addtid_b32 v81 offset:8320
  ds_write_addtid_b32 v85 offset:8576
  ds_write_addtid_b32 v89 offset:8832
  ds_write_addtid_b32 v93 offset:9088
  ds_read_b128 v[68:71], v3 offset:736
  s_waitcnt lgkmcnt(8)
  v_mfma_f32_32x32x16_bf16 v[176:191], v[72:75], v[44:47], v[176:191]
  ds_read_b32 v48, v5 offset:0
  ds_read_b128 v[72:75], v3 offset:864
  ds_read_b64_tr_b16 v[44:45], v2 offset:1440
  ds_read_b64_tr_b16 v[46:47], v2 offset:1408
  v_mfma_f32_32x32x16_bf16 v[96:111], a[12:15], v[32:35], v[96:111]
  ds_read_b32 v49, v5 offset:1040
  ds_read_b32 v50, v5 offset:2080
  v_mfma_f32_32x32x16_bf16 v[112:127], a[28:31], v[32:35], v[112:127]
  ds_read_b32 v51, v5 offset:3120
  s_waitcnt lgkmcnt(14)
  ds_read_b32 v52, v5 offset:4160
  s_waitcnt lgkmcnt(14)
  ds_read_b32 v53, v5 offset:5200
  v_mfma_f32_32x32x16_bf16 v[128:143], a[44:47], v[32:35], v[128:143]
  s_waitcnt lgkmcnt(14)
  ds_read_b32 v54, v5 offset:6240
  s_waitcnt lgkmcnt(14)
  ds_read_b32 v55, v5 offset:7280
  s_waitcnt lgkmcnt(14)
  ds_read_b64_tr_b16 v[32:33], v2 offset:544
  s_waitcnt lgkmcnt(14)
  ds_read_b64_tr_b16 v[34:35], v2 offset:512
  v_mfma_f32_32x32x16_bf16 v[96:111], a[8:11], v[36:39], v[96:111]
  s_waitcnt vmcnt(1)
  v_lshlrev_b32 v56, 16, v22
  v_and_b32 v57, v11, v22
  s_waitcnt lgkmcnt(12)
  v_mul_f32 v48, v48, v56
  v_mfma_f32_32x32x16_bf16 v[112:127], a[24:27], v[36:39], v[112:127]
  s_waitcnt lgkmcnt(8)
  v_mul_f32 v49, v49, v57
  v_cvt_pk_bf16_f32 v58, v48, v49
  v_mfma_f32_32x32x16_bf16 v[128:143], a[40:43], v[36:39], v[128:143]
  v_lshlrev_b32 v56, 16, v23
  v_and_b32 v57, v11, v23
  s_waitcnt lgkmcnt(7)
  v_mul_f32 v50, v50, v56
  ds_read_b64_tr_b16 v[36:37], v2 offset:672
  ds_read_b64_tr_b16 v[38:39], v2 offset:640
  v_mfma_f32_32x32x16_bf16 v[96:111], a[4:7], v[40:43], v[96:111]
  s_waitcnt lgkmcnt(8)
  v_mul_f32 v51, v51, v57
  v_cvt_pk_bf16_f32 v59, v50, v51
  v_mfma_f32_32x32x16_bf16 v[112:127], a[20:23], v[40:43], v[112:127]
  v_lshlrev_b32 v56, 16, v24
  v_and_b32 v57, v11, v24
  v_mfma_f32_32x32x16_bf16 v[128:143], a[36:39], v[40:43], v[128:143]
  s_waitcnt lgkmcnt(7)
  v_mul_f32 v52, v52, v56
  s_waitcnt lgkmcnt(6)
  v_mul_f32 v53, v53, v57
  v_cvt_pk_bf16_f32 v60, v52, v53
  ds_read_b64_tr_b16 v[40:41], v2 offset:800
  ds_read_b64_tr_b16 v[42:43], v2 offset:768
  v_mfma_f32_32x32x16_bf16 v[96:111], a[0:3], v[44:47], v[96:111]
  v_lshlrev_b32 v56, 16, v25
  v_and_b32 v57, v11, v25
  v_mfma_f32_32x32x16_bf16 v[112:127], a[16:19], v[44:47], v[112:127]
  s_waitcnt lgkmcnt(7)
  v_mul_f32 v54, v54, v56
  s_waitcnt lgkmcnt(6)
  v_mul_f32 v55, v55, v57
  v_cvt_pk_bf16_f32 v61, v54, v55
  v_mfma_f32_32x32x16_bf16 v[128:143], a[32:35], v[44:47], v[128:143]
  s_mov_b32 s46, 0
  buffer_store_dwordx4 v[58:61], v10, s[12:15], s46 offen
  s_nop 1
  s_add_u32 s48, s49, 122496
  s_mov_b32 m0, s48
  s_nop 0
  global_load_lds_dwordx4 v[12:13], off
  v_add_co_u32 v12, vcc, 0x50000, v12
  s_nop 1
  v_addc_co_u32 v13, vcc, 0, v13, vcc
  s_barrier
  s_setprio 2
  ds_read_b128 v[80:83], v3 offset:576
  ds_read_b128 v[84:87], v3 offset:704
  ds_read_b128 v[88:91], v3 offset:832
  ds_read_b64_tr_b16 v[44:45], v2 offset:928
  ds_read_b64_tr_b16 v[46:47], v2 offset:896
  s_waitcnt lgkmcnt(9)
  v_mfma_f32_32x32x16_bf16 v[144:159], v[64:67], v[32:35], v[144:159]
  ds_read_b32 v48, v7 offset:32896
  ds_read_b32 v49, v7 offset:33024
  ds_read_b32 v50, v7 offset:33152
  ds_read_b32 v51, v6 offset:32768
  ds_read_b32 v52, v6 offset:32896
  ds_read_b128 v[64:67], v3 offset:544
  v_mfma_f32_32x32x16_bf16 v[160:175], v[68:71], v[32:35], v[160:175]
  s_waitcnt lgkmcnt(14)
  ds_read_b32 v53, v6 offset:33024
  s_waitcnt lgkmcnt(14)
  ds_read_b32 v54, v6 offset:33152
  s_waitcnt lgkmcnt(14)
  ds_read_b32 v55, v6 offset:33280
  s_waitcnt lgkmcnt(14)
  ds_read_b32 v56, v6 offset:33408
  s_waitcnt lgkmcnt(14)
  ds_read_b32 v57, v6 offset:33536
  s_waitcnt lgkmcnt(14)
  ds_read_b32 v58, v6 offset:33664
  s_waitcnt lgkmcnt(14)
  ds_read_b128 v[68:71], v3 offset:672
  v_mfma_f32_32x32x16_bf16 v[176:191], v[72:75], v[32:35], v[176:191]
  s_waitcnt lgkmcnt(12)
  v_lshlrev_b32 v28, 16, v48
  v_and_b32 v29, v11, v48
  v_mul_f32 v59, v28, v17
  v_mul_f32 v60, v29, v21
  s_waitcnt lgkmcnt(11)
  v_lshlrev_b32 v28, 16, v49
  ds_read_b128 v[72:75], v3 offset:800
  ds_read_b64_tr_b16 v[32:33], v2 offset:1568
  ds_read_b64_tr_b16 v[34:35], v2 offset:1536
  v_mfma_f32_32x32x16_bf16 v[144:159], v[80:83], v[36:39], v[144:159]
  v_and_b32 v29, v11, v49
  v_fmac_f32 v59, v28, v16
  v_fmac_f32 v60, v29, v20
  v_mul_f32 v61, v28, v17
  v_mul_f32 v62, v29, v21
  s_waitcnt lgkmcnt(13)
  v_lshlrev_b32 v28, 16, v50
  ds_read_b128 v[80:83], v3 offset:512
  v_mfma_f32_32x32x16_bf16 v[160:175], v[84:87], v[36:39], v[160:175]
  v_and_b32 v29, v11, v50
  v_fmac_f32 v59, v28, v15
  v_fmac_f32 v60, v29, v19
  v_fmac_f32 v61, v28, v16
  v_fmac_f32 v62, v29, v20
  ds_read_b128 v[84:87], v3 offset:640
  v_mfma_f32_32x32x16_bf16 v[176:191], v[88:91], v[36:39], v[176:191]
  v_mul_f32 v63, v28, v17
  v_mul_f32 v0, v29, v21
  s_waitcnt lgkmcnt(14)
  v_lshlrev_b32 v28, 16, v51
  v_and_b32 v29, v11, v51
  v_fmac_f32 v59, v28, v14
  v_fmac_f32 v60, v29, v18
  ds_read_b128 v[88:91], v3 offset:768
  s_waitcnt lgkmcnt(14)
  ds_read_b64_tr_b16 v[36:37], v2 offset:1696
  s_waitcnt lgkmcnt(14)
  ds_read_b64_tr_b16 v[38:39], v2 offset:1664
  v_mfma_f32_32x32x16_bf16 v[144:159], v[64:67], v[40:43], v[144:159]
  v_fmac_f32 v61, v28, v15
  v_fmac_f32 v62, v29, v19
  v_fmac_f32 v63, v28, v16
  v_fmac_f32 v0, v29, v20
  v_mul_f32 v1, v28, v17
  s_waitcnt lgkmcnt(14)
  ds_read_b128 v[64:67], v3 offset:608
  s_waitcnt lgkmcnt(9)
  v_mfma_f32_32x32x16_bf16 v[160:175], v[68:71], v[40:43], v[160:175]
  v_mul_f32 v31, v29, v21
  v_lshlrev_b32 v28, 16, v52
  v_and_b32 v29, v11, v52
  v_fmac_f32 v61, v28, v14
  v_fmac_f32 v62, v29, v18
  v_fmac_f32 v63, v28, v15
  ds_read_b128 v[68:71], v3 offset:736
  s_waitcnt lgkmcnt(9)
  v_mfma_f32_32x32x16_bf16 v[176:191], v[72:75], v[40:43], v[176:191]
  v_fmac_f32 v0, v29, v19
  v_fmac_f32 v1, v28, v16
  v_fmac_f32 v31, v29, v20
  v_lshlrev_b32 v28, 16, v53
  v_and_b32 v29, v11, v53
  ds_read_b128 v[72:75], v3 offset:576
  ds_read_b64_tr_b16 v[40:41], v2 offset:1824
  ds_read_b64_tr_b16 v[42:43], v2 offset:1792
  s_waitcnt lgkmcnt(9)
  v_mfma_f32_32x32x16_bf16 v[144:159], v[80:83], v[44:47], v[144:159]
  v_fmac_f32 v63, v28, v14
  v_fmac_f32 v0, v29, v18
  v_fmac_f32 v1, v28, v15
  v_fmac_f32 v31, v29, v19
  v_lshlrev_b32 v28, 16, v54
  v_and_b32 v29, v11, v54
  ds_read_b128 v[80:83], v3 offset:704
  s_waitcnt lgkmcnt(9)
  v_mfma_f32_32x32x16_bf16 v[160:175], v[84:87], v[44:47], v[160:175]
  v_fmac_f32 v1, v28, v14
  v_fmac_f32 v31, v29, v18
  v_lshlrev_b32 v48, 16, v55
  v_and_b32 v55, v11, v55
  v_lshlrev_b32 v49, 16, v56
  ds_read_b128 v[84:87], v3 offset:544
  s_waitcnt lgkmcnt(9)
  v_mfma_f32_32x32x16_bf16 v[176:191], v[88:91], v[44:47], v[176:191]
  v_and_b32 v56, v11, v56
  v_lshlrev_b32 v50, 16, v57
  v_and_b32 v57, v11, v57
  v_lshlrev_b32 v51, 16, v58
  v_and_b32 v58, v11, v58
  ds_read_b128 v[88:91], v3 offset:672
  ds_read_b64_tr_b16 v[44:45], v2 offset:1952
  ds_read_b64_tr_b16 v[46:47], v2 offset:1920
  v_mfma_f32_32x32x16_bf16 v[112:127], a[12:15], v[32:35], v[112:127]
  v_mul_f32 v59, v59, v48
  v_mul_f32 v60, v60, v55
  v_mul_f32 v61, v61, v49
  v_mul_f32 v62, v62, v56
  v_mul_f32 v63, v63, v50
  v_mul_f32 v0, v0, v57
  v_mfma_f32_32x32x16_bf16 v[128:143], a[28:31], v[32:35], v[128:143]
  v_mul_f32 v1, v1, v51
  v_mul_f32 v31, v31, v58
  v_cvt_pk_bf16_f32 v48, v59, v61
  v_cvt_pk_bf16_f32 v49, v63, v1
  v_cvt_pk_bf16_f32 v50, v60, v62
  ds_read_b64_tr_b16 v[32:33], v2 offset:1056
  ds_read_b64_tr_b16 v[34:35], v2 offset:1024
  s_waitcnt lgkmcnt(12)
  v_mfma_f32_32x32x16_bf16 v[112:127], a[8:11], v[36:39], v[112:127]
  v_cvt_pk_bf16_f32 v51, v0, v31
  ds_write_b64 v8, v[48:49] offset:2048
  ds_write_b64 v8, v[50:51] offset:6224
  v_add_f32_dpp v28, v95, v98 wave_ror:1 row_mask:0x1 bank_mask:0x1
  v_add_f32_dpp v28, v99, v98 wave_shr:1 row_mask:0xf bank_mask:0xf
  v_mfma_f32_32x32x16_bf16 v[128:143], a[24:27], v[36:39], v[128:143]
  v_add_f32_dpp v29, v99, v102 wave_ror:1 row_mask:0x1 bank_mask:0x1
  v_add_f32_dpp v29, v103, v102 wave_shr:1 row_mask:0xf bank_mask:0xf
  v_add_f32_dpp v30, v103, v106 wave_ror:1 row_mask:0x1 bank_mask:0x1
  v_add_f32_dpp v30, v107, v106 wave_shr:1 row_mask:0xf bank_mask:0xf
  v_add_f32_dpp v26, v107, v110 wave_ror:1 row_mask:0x1 bank_mask:0x1
  v_add_f32_dpp v26, v111, v110 wave_shr:1 row_mask:0xf bank_mask:0xf
  ds_read_b64_tr_b16 v[36:37], v2 offset:1184
  s_waitcnt lgkmcnt(14)
  ds_read_b64_tr_b16 v[38:39], v2 offset:1152
  s_waitcnt lgkmcnt(11)
  v_mfma_f32_32x32x16_bf16 v[112:127], a[4:7], v[40:43], v[112:127]
  v_add_f32_dpp v98, v27, v97 wave_ror:1 row_mask:0x1 bank_mask:0x1
  v_add_f32_dpp v98, v28, v97 wave_shr:1 row_mask:0xf bank_mask:0xf
  v_add_f32_dpp v102, v28, v101 wave_ror:1 row_mask:0x1 bank_mask:0x1
  v_add_f32_dpp v102, v29, v101 wave_shr:1 row_mask:0xf bank_mask:0xf
  v_add_f32_dpp v106, v29, v105 wave_ror:1 row_mask:0x1 bank_mask:0x1
  v_add_f32_dpp v106, v30, v105 wave_shr:1 row_mask:0xf bank_mask:0xf
  v_mfma_f32_32x32x16_bf16 v[128:143], a[20:23], v[40:43], v[128:143]
  v_add_f32_dpp v110, v30, v109 wave_ror:1 row_mask:0x1 bank_mask:0x1
  v_add_f32_dpp v110, v26, v109 wave_shr:1 row_mask:0xf bank_mask:0xf
  v_add_f32_dpp v97, v94, v96 wave_ror:1 row_mask:0x1 bank_mask:0x1
  v_add_f32_dpp v97, v98, v96 wave_shr:1 row_mask:0xf bank_mask:0xf
  v_add_f32_dpp v101, v98, v100 wave_ror:1 row_mask:0x1 bank_mask:0x1
  v_add_f32_dpp v101, v102, v100 wave_shr:1 row_mask:0xf bank_mask:0xf
  ds_read_b64_tr_b16 v[40:41], v2 offset:1312
  ds_read_b64_tr_b16 v[42:43], v2 offset:1280
  s_waitcnt lgkmcnt(8)
  v_mfma_f32_32x32x16_bf16 v[112:127], a[0:3], v[44:47], v[112:127]
  v_add_f32_dpp v105, v102, v104 wave_ror:1 row_mask:0x1 bank_mask:0x1
  v_add_f32_dpp v105, v106, v104 wave_shr:1 row_mask:0xf bank_mask:0xf
  v_add_f32_dpp v109, v106, v108 wave_ror:1 row_mask:0x1 bank_mask:0x1
  v_add_f32_dpp v109, v110, v108 wave_shr:1 row_mask:0xf bank_mask:0xf
  v_mfma_f32_32x32x16_bf16 v[128:143], a[16:19], v[44:47], v[128:143]
  s_mov_b32 m0, s47
  s_nop 0
  ds_write_addtid_b32 v97 offset:16640
  ds_write_addtid_b32 v101 offset:16896
  ds_write_addtid_b32 v105 offset:17152
  ds_write_addtid_b32 v109 offset:17408
  s_mov_b32 s46, 655360
  buffer_load_dwordx4 v[22:25], v9, s[8:11], s46 offen
  s_add_u32 s48, s49, 130688
  s_mov_b32 m0, s48
  s_nop 0
  global_load_lds_dwordx4 v[12:13], off
  v_add_co_u32 v12, vcc, 0x50000, v12
  s_nop 1
  v_addc_co_u32 v13, vcc, 0, v13, vcc
  s_waitcnt vmcnt(4) lgkmcnt(0)
  s_barrier
  s_setprio 0
  ds_read_b64_tr_b16 v[44:45], v2 offset:1440
  ds_read_b64_tr_b16 v[46:47], v2 offset:1408
  v_mfma_f32_32x32x16_bf16 v[144:159], a[60:63], v[32:35], v[144:159]
  v_add_f32_dpp v28, v111, v114 wave_ror:1 row_mask:0x1 bank_mask:0x1
  v_add_f32_dpp v28, v115, v114 wave_shr:1 row_mask:0xf bank_mask:0xf
  v_mfma_f32_32x32x16_bf16 v[160:175], v[64:67], v[32:35], v[160:175]
  v_add_f32_dpp v29, v115, v118 wave_ror:1 row_mask:0x1 bank_mask:0x1
  v_add_f32_dpp v29, v119, v118 wave_shr:1 row_mask:0xf bank_mask:0xf
  ds_read_b128 v[64:67], v3 offset:512
  v_mfma_f32_32x32x16_bf16 v[176:191], v[68:71], v[32:35], v[176:191]
  v_add_f32_dpp v30, v119, v122 wave_ror:1 row_mask:0x1 bank_mask:0x1
  v_add_f32_dpp v30, v123, v122 wave_shr:1 row_mask:0xf bank_mask:0xf
  v_add_f32_dpp v27, v123, v126 wave_ror:1 row_mask:0x1 bank_mask:0x1
  v_add_f32_dpp v27, v127, v126 wave_shr:1 row_mask:0xf bank_mask:0xf
  ds_read_b128 v[68:71], v3 offset:640
  ds_read_b64_tr_b16 v[32:33], v2 offset:1568
  ds_read_b64_tr_b16 v[34:35], v2 offset:1536
  v_mfma_f32_32x32x16_bf16 v[144:159], a[56:59], v[36:39], v[144:159]
  v_add_f32_dpp v114, v26, v113 wave_ror:1 row_mask:0x1 bank_mask:0x1
  v_add_f32_dpp v114, v28, v113 wave_shr:1 row_mask:0xf bank_mask:0xf
  v_mfma_f32_32x32x16_bf16 v[160:175], v[72:75], v[36:39], v[160:175]
  v_add_f32_dpp v118, v28, v117 wave_ror:1 row_mask:0x1 bank_mask:0x1
  v_add_f32_dpp v118, v29, v117 wave_shr:1 row_mask:0xf bank_mask:0xf
  v_mfma_f32_32x32x16_bf16 v[176:191], v[80:83], v[36:39], v[176:191]
  v_add_f32_dpp v122, v29, v121 wave_ror:1 row_mask:0x1 bank_mask:0x1
  v_add_f32_dpp v122, v30, v121 wave_shr:1 row_mask:0xf bank_mask:0xf
  ds_read_b64_tr_b16 v[36:37], v2 offset:1696
  ds_read_b64_tr_b16 v[38:39], v2 offset:1664
  v_mfma_f32_32x32x16_bf16 v[144:159], a[52:55], v[40:43], v[144:159]
  v_add_f32_dpp v126, v30, v125 wave_ror:1 row_mask:0x1 bank_mask:0x1
  v_add_f32_dpp v126, v27, v125 wave_shr:1 row_mask:0xf bank_mask:0xf
  v_mfma_f32_32x32x16_bf16 v[160:175], v[84:87], v[40:43], v[160:175]
  v_add_f32_dpp v113, v110, v112 wave_ror:1 row_mask:0x1 bank_mask:0x1
  v_add_f32_dpp v113, v114, v112 wave_shr:1 row_mask:0xf bank_mask:0xf
  v_add_f32_dpp v117, v114, v116 wave_ror:1 row_mask:0x1 bank_mask:0x1
  v_add_f32_dpp v117, v118, v116 wave_shr:1 row_mask:0xf bank_mask:0xf
  v_mfma_f32_32x32x16_bf16 v[176:191], v[88:91], v[40:43], v[176:191]
  v_add_f32_dpp v121, v118, v120 wave_ror:1 row_mask:0x1 bank_mask:0x1
  v_add_f32_dpp v121, v122, v120 wave_shr:1 row_mask:0xf bank_mask:0xf
  ds_read_b64_tr_b16 v[40:41], v2 offset:1824
  ds_read_b64_tr_b16 v[42:43], v2 offset:1792
  s_waitcnt lgkmcnt(8)
  v_mfma_f32_32x32x16_bf16 v[144:159], a[48:51], v[44:47], v[144:159]
  v_add_f32_dpp v125, v122, v124 wave_ror:1 row_mask:0x1 bank_mask:0x1
  v_add_f32_dpp v125, v126, v124 wave_shr:1 row_mask:0xf bank_mask:0xf
  s_waitcnt lgkmcnt(7)
  v_mfma_f32_32x32x16_bf16 v[160:175], v[64:67], v[44:47], v[160:175]
  s_mov_b32 m0, s47
  s_nop 0
  ds_write_addtid_b32 v113 offset:0
  ds_write_addtid_b32 v117 offset:256
  ds_write_addtid_b32 v121 offset:512
  ds_write_addtid_b32 v125 offset:768
  s_waitcnt lgkmcnt(10)
  v_mfma_f32_32x32x16_bf16 v[176:191], v[68:71], v[44:47], v[176:191]
  ds_read_b32 v48, v5 offset:16640
  ds_read_b64_tr_b16 v[44:45], v2 offset:1952
  ds_read_b64_tr_b16 v[46:47], v2 offset:1920
  s_waitcnt lgkmcnt(11)
  v_mfma_f32_32x32x16_bf16 v[144:159], a[44:47], v[32:35], v[144:159]
  ds_read_b32 v49, v5 offset:17680
  ds_read_b32 v50, v5 offset:18720
  v_mfma_f32_32x32x16_bf16 v[160:175], a[60:63], v[32:35], v[160:175]
  ds_read_b32 v51, v5 offset:19760
  ds_read_b32 v52, v5 offset:20800
  s_waitcnt lgkmcnt(14)
  ds_read_b32 v53, v5 offset:21840
  s_waitcnt lgkmcnt(14)
  ds_read_b64_tr_b16 v[32:33], v2 offset:2080
  s_waitcnt lgkmcnt(14)
  ds_read_b64_tr_b16 v[34:35], v2 offset:2048
  v_mfma_f32_32x32x16_bf16 v[144:159], a[40:43], v[36:39], v[144:159]
  s_waitcnt lgkmcnt(14)
  ds_read_b32 v54, v5 offset:22880
  s_waitcnt lgkmcnt(14)
  ds_read_b32 v55, v5 offset:23920
  v_mfma_f32_32x32x16_bf16 v[160:175], a[56:59], v[36:39], v[160:175]
  s_waitcnt vmcnt(1)
  v_lshlrev_b32 v56, 16, v22
  v_and_b32 v57, v11, v22
  s_waitcnt lgkmcnt(11)
  v_mul_f32 v48, v48, v56
  ds_read_b64_tr_b16 v[36:37], v2 offset:2208
  ds_read_b64_tr_b16 v[38:39], v2 offset:2176
  v_mfma_f32_32x32x16_bf16 v[144:159], a[36:39], v[40:43], v[144:159]
  s_waitcnt lgkmcnt(10)
  v_mul_f32 v49, v49, v57
  v_cvt_pk_bf16_f32 v58, v48, v49
  v_mfma_f32_32x32x16_bf16 v[160:175], a[52:55], v[40:43], v[160:175]
  v_lshlrev_b32 v56, 16, v23
  v_and_b32 v57, v11, v23
  s_waitcnt lgkmcnt(9)
  v_mul_f32 v50, v50, v56
  ds_read_b64_tr_b16 v[40:41], v2 offset:2336
  ds_read_b64_tr_b16 v[42:43], v2 offset:2304
  v_mfma_f32_32x32x16_bf16 v[144:159], a[32:35], v[44:47], v[144:159]
  s_waitcnt lgkmcnt(10)
  v_mul_f32 v51, v51, v57
  v_cvt_pk_bf16_f32 v59, v50, v51
  v_mfma_f32_32x32x16_bf16 v[160:175], a[48:51], v[44:47], v[160:175]
  v_lshlrev_b32 v56, 16, v24
  v_and_b32 v57, v11, v24
  ds_read_b64_tr_b16 v[44:45], v2 offset:2464
  ds_read_b64_tr_b16 v[46:47], v2 offset:2432
  s_waitcnt lgkmcnt(8)
  v_mfma_f32_32x32x16_bf16 v[128:143], a[12:15], v[32:35], v[128:143]
  v_mul_f32 v52, v52, v56
  v_mul_f32 v53, v53, v57
  v_cvt_pk_bf16_f32 v60, v52, v53
  ds_read_b64_tr_b16 v[32:33], v2 offset:2080
  ds_read_b64_tr_b16 v[34:35], v2 offset:2048
  s_waitcnt lgkmcnt(6)
  v_mfma_f32_32x32x16_bf16 v[128:143], a[8:11], v[36:39], v[128:143]
  v_lshlrev_b32 v56, 16, v25
  v_and_b32 v57, v11, v25
  ds_read_b64_tr_b16 v[36:37], v2 offset:2208
  ds_read_b64_tr_b16 v[38:39], v2 offset:2176
  s_waitcnt lgkmcnt(6)
  v_mfma_f32_32x32x16_bf16 v[128:143], a[4:7], v[40:43], v[128:143]
  v_mul_f32 v54, v54, v56
  v_mul_f32 v55, v55, v57
  v_cvt_pk_bf16_f32 v61, v54, v55
  ds_read_b64_tr_b16 v[40:41], v2 offset:2336
  ds_read_b64_tr_b16 v[42:43], v2 offset:2304
  s_waitcnt lgkmcnt(6)
  v_mfma_f32_32x32x16_bf16 v[128:143], a[0:3], v[44:47], v[128:143]
  s_mov_b32 s46, 1310720
  buffer_store_dwordx4 v[58:61], v10, s[12:15], s46 offen
  s_nop 1
  s_barrier
  s_setprio 2
  ds_read_b128 v[72:75], v3 offset:608
  ds_read_b128 v[80:83], v3 offset:576
  ds_read_b128 v[84:87], v3 offset:544
  ds_read_b128 v[88:91], v3 offset:512
  ds_read_b64_tr_b16 v[44:45], v2 offset:2464
  ds_read_b64_tr_b16 v[46:47], v2 offset:2432
  s_waitcnt lgkmcnt(10)
  v_mfma_f32_32x32x16_bf16 v[144:159], a[28:31], v[32:35], v[144:159]
  ds_read_b32 v48, v7 offset:49280
  ds_read_b32 v49, v7 offset:49408
  ds_read_b32 v50, v7 offset:49536
  ds_read_b32 v51, v6 offset:49152
  ds_read_b32 v52, v6 offset:49280
  v_mfma_f32_32x32x16_bf16 v[160:175], a[44:47], v[32:35], v[160:175]
  s_waitcnt lgkmcnt(14)
  ds_read_b32 v53, v6 offset:49408
  s_waitcnt lgkmcnt(14)
  ds_read_b32 v54, v6 offset:49536
  s_waitcnt lgkmcnt(14)
  ds_read_b32 v55, v6 offset:49664
  s_waitcnt lgkmcnt(14)
  ds_read_b32 v56, v6 offset:49792
  s_waitcnt lgkmcnt(14)
  ds_read_b32 v57, v6 offset:49920
  s_waitcnt lgkmcnt(14)
  ds_read_b32 v58, v6 offset:50048
  v_mfma_f32_32x32x16_bf16 v[176:191], a[60:63], v[32:35], v[176:191]
  s_waitcnt lgkmcnt(10)
  v_lshlrev_b32 v28, 16, v48
  v_and_b32 v29, v11, v48
  v_mul_f32 v59, v28, v17
  v_mul_f32 v60, v29, v21
  s_waitcnt lgkmcnt(9)
  v_lshlrev_b32 v28, 16, v49
  ds_read_b64_tr_b16 v[32:33], v2 offset:2592
  ds_read_b64_tr_b16 v[34:35], v2 offset:2560
  v_mfma_f32_32x32x16_bf16 v[144:159], a[24:27], v[36:39], v[144:159]
  v_and_b32 v29, v11, v49
  v_fmac_f32 v59, v28, v16
  v_fmac_f32 v60, v29, v20
  v_mul_f32 v61, v28, v17
  v_mul_f32 v62, v29, v21
  s_waitcnt lgkmcnt(10)
  v_lshlrev_b32 v28, 16, v50
  v_mfma_f32_32x32x16_bf16 v[160:175], a[40:43], v[36:39], v[160:175]
  v_and_b32 v29, v11, v50
  v_fmac_f32 v59, v28, v15
  v_fmac_f32 v60, v29, v19
  v_fmac_f32 v61, v28, v16
  v_fmac_f32 v62, v29, v20
  v_mfma_f32_32x32x16_bf16 v[176:191], a[56:59], v[36:39], v[176:191]
  v_mul_f32 v63, v28, v17
  v_mul_f32 v0, v29, v21
  s_waitcnt lgkmcnt(9)
  v_lshlrev_b32 v28, 16, v51
  v_and_b32 v29, v11, v51
  v_fmac_f32 v59, v28, v14
  v_fmac_f32 v60, v29, v18
  ds_read_b64_tr_b16 v[36:37], v2 offset:2720
  ds_read_b64_tr_b16 v[38:39], v2 offset:2688
  v_mfma_f32_32x32x16_bf16 v[144:159], a[20:23], v[40:43], v[144:159]
  v_fmac_f32 v61, v28, v15
  v_fmac_f32 v62, v29, v19
  v_fmac_f32 v63, v28, v16
  v_fmac_f32 v0, v29, v20
  v_mul_f32 v1, v28, v17
  v_mfma_f32_32x32x16_bf16 v[160:175], a[36:39], v[40:43], v[160:175]
  v_mul_f32 v31, v29, v21
  s_waitcnt lgkmcnt(10)
  v_lshlrev_b32 v28, 16, v52
  v_and_b32 v29, v11, v52
  v_fmac_f32 v61, v28, v14
  v_fmac_f32 v62, v29, v18
  v_fmac_f32 v63, v28, v15
  v_mfma_f32_32x32x16_bf16 v[176:191], a[52:55], v[40:43], v[176:191]
  v_fmac_f32 v0, v29, v19
  v_fmac_f32 v1, v28, v16
  v_fmac_f32 v31, v29, v20
  s_waitcnt lgkmcnt(9)
  v_lshlrev_b32 v28, 16, v53
  v_and_b32 v29, v11, v53
  ds_read_b64_tr_b16 v[40:41], v2 offset:2848
  ds_read_b64_tr_b16 v[42:43], v2 offset:2816
  v_mfma_f32_32x32x16_bf16 v[144:159], a[16:19], v[44:47], v[144:159]
  v_fmac_f32 v63, v28, v14
  v_fmac_f32 v0, v29, v18
  v_fmac_f32 v1, v28, v15
  v_fmac_f32 v31, v29, v19
  s_waitcnt lgkmcnt(10)
  v_lshlrev_b32 v28, 16, v54
  v_and_b32 v29, v11, v54
  v_mfma_f32_32x32x16_bf16 v[160:175], a[32:35], v[44:47], v[160:175]
  v_fmac_f32 v1, v28, v14
  v_fmac_f32 v31, v29, v18
  s_waitcnt lgkmcnt(9)
  v_lshlrev_b32 v48, 16, v55
  v_and_b32 v55, v11, v55
  s_waitcnt lgkmcnt(8)
  v_lshlrev_b32 v49, 16, v56
  v_mfma_f32_32x32x16_bf16 v[176:191], a[48:51], v[44:47], v[176:191]
  v_and_b32 v56, v11, v56
  s_waitcnt lgkmcnt(7)
  v_lshlrev_b32 v50, 16, v57
  v_and_b32 v57, v11, v57
  s_waitcnt lgkmcnt(6)
  v_lshlrev_b32 v51, 16, v58
  v_and_b32 v58, v11, v58
  ds_read_b64_tr_b16 v[44:45], v2 offset:2976
  ds_read_b64_tr_b16 v[46:47], v2 offset:2944
  s_waitcnt lgkmcnt(6)
  v_mfma_f32_32x32x16_bf16 v[144:159], a[12:15], v[32:35], v[144:159]
  v_mul_f32 v59, v59, v48
  v_mul_f32 v60, v60, v55
  v_mul_f32 v61, v61, v49
  v_mul_f32 v62, v62, v56
  v_mul_f32 v63, v63, v50
  v_mul_f32 v0, v0, v57
  v_mfma_f32_32x32x16_bf16 v[160:175], a[28:31], v[32:35], v[160:175]
  v_mul_f32 v1, v1, v51
  v_mul_f32 v31, v31, v58
  v_cvt_pk_bf16_f32 v48, v59, v61
  v_cvt_pk_bf16_f32 v49, v63, v1
  v_cvt_pk_bf16_f32 v50, v60, v62
  ds_read_b64_tr_b16 v[32:33], v2 offset:1568
  ds_read_b64_tr_b16 v[34:35], v2 offset:1536
  s_waitcnt lgkmcnt(6)
  v_mfma_f32_32x32x16_bf16 v[144:159], a[8:11], v[36:39], v[144:159]
  v_cvt_pk_bf16_f32 v51, v0, v31
  ds_write_b64 v8, v[48:49] offset:3072
  ds_write_b64 v8, v[50:51] offset:7248
  v_add_f32_dpp v28, v127, v130 wave_ror:1 row_mask:0x1 bank_mask:0x1
  v_add_f32_dpp v28, v131, v130 wave_shr:1 row_mask:0xf bank_mask:0xf
  v_mfma_f32_32x32x16_bf16 v[160:175], a[24:27], v[36:39], v[160:175]
  v_add_f32_dpp v29, v131, v134 wave_ror:1 row_mask:0x1 bank_mask:0x1
  v_add_f32_dpp v29, v135, v134 wave_shr:1 row_mask:0xf bank_mask:0xf
  v_add_f32_dpp v30, v135, v138 wave_ror:1 row_mask:0x1 bank_mask:0x1
  v_add_f32_dpp v30, v139, v138 wave_shr:1 row_mask:0xf bank_mask:0xf
  v_add_f32_dpp v26, v139, v142 wave_ror:1 row_mask:0x1 bank_mask:0x1
  v_add_f32_dpp v26, v143, v142 wave_shr:1 row_mask:0xf bank_mask:0xf
  ds_read_b64_tr_b16 v[36:37], v2 offset:1696
  ds_read_b64_tr_b16 v[38:39], v2 offset:1664
  s_waitcnt lgkmcnt(8)
  v_mfma_f32_32x32x16_bf16 v[144:159], a[4:7], v[40:43], v[144:159]
  v_add_f32_dpp v130, v27, v129 wave_ror:1 row_mask:0x1 bank_mask:0x1
  v_add_f32_dpp v130, v28, v129 wave_shr:1 row_mask:0xf bank_mask:0xf
  v_add_f32_dpp v134, v28, v133 wave_ror:1 row_mask:0x1 bank_mask:0x1
  v_add_f32_dpp v134, v29, v133 wave_shr:1 row_mask:0xf bank_mask:0xf
  v_add_f32_dpp v138, v29, v137 wave_ror:1 row_mask:0x1 bank_mask:0x1
  v_add_f32_dpp v138, v30, v137 wave_shr:1 row_mask:0xf bank_mask:0xf
  v_mfma_f32_32x32x16_bf16 v[160:175], a[20:23], v[40:43], v[160:175]
  v_add_f32_dpp v142, v30, v141 wave_ror:1 row_mask:0x1 bank_mask:0x1
  v_add_f32_dpp v142, v26, v141 wave_shr:1 row_mask:0xf bank_mask:0xf
  v_add_f32_dpp v129, v126, v128 wave_ror:1 row_mask:0x1 bank_mask:0x1
  v_add_f32_dpp v129, v130, v128 wave_shr:1 row_mask:0xf bank_mask:0xf
  v_add_f32_dpp v133, v130, v132 wave_ror:1 row_mask:0x1 bank_mask:0x1
  v_add_f32_dpp v133, v134, v132 wave_shr:1 row_mask:0xf bank_mask:0xf
  ds_read_b64_tr_b16 v[40:41], v2 offset:1824
  ds_read_b64_tr_b16 v[42:43], v2 offset:1792
  s_waitcnt lgkmcnt(8)
  v_mfma_f32_32x32x16_bf16 v[144:159], a[0:3], v[44:47], v[144:159]
  v_add_f32_dpp v137, v134, v136 wave_ror:1 row_mask:0x1 bank_mask:0x1
  v_add_f32_dpp v137, v138, v136 wave_shr:1 row_mask:0xf bank_mask:0xf
  v_add_f32_dpp v141, v138, v140 wave_ror:1 row_mask:0x1 bank_mask:0x1
  v_add_f32_dpp v141, v142, v140 wave_shr:1 row_mask:0xf bank_mask:0xf
  v_mfma_f32_32x32x16_bf16 v[160:175], a[16:19], v[44:47], v[160:175]
  s_mov_b32 m0, s47
  s_nop 0
  ds_write_addtid_b32 v129 offset:8320
  ds_write_addtid_b32 v133 offset:8576
  ds_write_addtid_b32 v137 offset:8832
  ds_write_addtid_b32 v141 offset:9088
  s_mov_b32 s46, 1310720
  buffer_load_dwordx4 v[22:25], v9, s[8:11], s46 offen
  s_waitcnt vmcnt(2) lgkmcnt(0)
  s_barrier
  s_setprio 0
  ds_read_b64_tr_b16 v[44:45], v2 offset:1952
  ds_read_b64_tr_b16 v[46:47], v2 offset:1920
  v_mfma_f32_32x32x16_bf16 v[176:191], v[72:75], v[32:35], v[176:191]
  v_add_f32_dpp v28, v143, v146 wave_ror:1 row_mask:0x1 bank_mask:0x1
  v_add_f32_dpp v28, v147, v146 wave_shr:1 row_mask:0xf bank_mask:0xf
  v_add_f32_dpp v29, v147, v150 wave_ror:1 row_mask:0x1 bank_mask:0x1
  v_add_f32_dpp v29, v151, v150 wave_shr:1 row_mask:0xf bank_mask:0xf
  ds_read_b64_tr_b16 v[32:33], v2 offset:3104
  ds_read_b64_tr_b16 v[34:35], v2 offset:3072
  v_mfma_f32_32x32x16_bf16 v[176:191], v[80:83], v[36:39], v[176:191]
  v_add_f32_dpp v30, v151, v154 wave_ror:1 row_mask:0x1 bank_mask:0x1
  v_add_f32_dpp v30, v155, v154 wave_shr:1 row_mask:0xf bank_mask:0xf
  v_add_f32_dpp v27, v155, v158 wave_ror:1 row_mask:0x1 bank_mask:0x1
  v_add_f32_dpp v27, v159, v158 wave_shr:1 row_mask:0xf bank_mask:0xf
  v_add_f32_dpp v146, v26, v145 wave_ror:1 row_mask:0x1 bank_mask:0x1
  v_add_f32_dpp v146, v28, v145 wave_shr:1 row_mask:0xf bank_mask:0xf
  ds_read_b64_tr_b16 v[36:37], v2 offset:3232
  ds_read_b64_tr_b16 v[38:39], v2 offset:3200
  v_mfma_f32_32x32x16_bf16 v[176:191], v[84:87], v[40:43], v[176:191]
  v_add_f32_dpp v150, v28, v149 wave_ror:1 row_mask:0x1 bank_mask:0x1
  v_add_f32_dpp v150, v29, v149 wave_shr:1 row_mask:0xf bank_mask:0xf
  v_add_f32_dpp v154, v29, v153 wave_ror:1 row_mask:0x1 bank_mask:0x1
  v_add_f32_dpp v154, v30, v153 wave_shr:1 row_mask:0xf bank_mask:0xf
  ds_read_b64_tr_b16 v[40:41], v2 offset:3360
  ds_read_b64_tr_b16 v[42:43], v2 offset:3328
  s_waitcnt lgkmcnt(6)
  v_mfma_f32_32x32x16_bf16 v[176:191], v[88:91], v[44:47], v[176:191]
  v_add_f32_dpp v158, v30, v157 wave_ror:1 row_mask:0x1 bank_mask:0x1
  v_add_f32_dpp v158, v27, v157 wave_shr:1 row_mask:0xf bank_mask:0xf
  v_add_f32_dpp v145, v142, v144 wave_ror:1 row_mask:0x1 bank_mask:0x1
  v_add_f32_dpp v145, v146, v144 wave_shr:1 row_mask:0xf bank_mask:0xf
  v_add_f32_dpp v149, v146, v148 wave_ror:1 row_mask:0x1 bank_mask:0x1
  v_add_f32_dpp v149, v150, v148 wave_shr:1 row_mask:0xf bank_mask:0xf
  ds_read_b64_tr_b16 v[44:45], v2 offset:3488
  ds_read_b64_tr_b16 v[46:47], v2 offset:3456
  s_waitcnt lgkmcnt(6)
  v_mfma_f32_32x32x16_bf16 v[160:175], a[12:15], v[32:35], v[160:175]
  v_add_f32_dpp v153, v150, v152 wave_ror:1 row_mask:0x1 bank_mask:0x1
  v_add_f32_dpp v153, v154, v152 wave_shr:1 row_mask:0xf bank_mask:0xf
  v_add_f32_dpp v157, v154, v156 wave_ror:1 row_mask:0x1 bank_mask:0x1
  v_add_f32_dpp v157, v158, v156 wave_shr:1 row_mask:0xf bank_mask:0xf
  v_mfma_f32_32x32x16_bf16 v[176:191], a[28:31], v[32:35], v[176:191]
  s_mov_b32 m0, s47
  s_nop 0
  ds_write_addtid_b32 v145 offset:16640
  ds_write_addtid_b32 v149 offset:16896
  ds_write_addtid_b32 v153 offset:17152
  ds_write_addtid_b32 v157 offset:17408
  ds_read_b32 v48, v5 offset:8320
  ds_read_b64_tr_b16 v[32:33], v2 offset:2592
  ds_read_b64_tr_b16 v[34:35], v2 offset:2560
  s_waitcnt lgkmcnt(11)
  v_mfma_f32_32x32x16_bf16 v[160:175], a[8:11], v[36:39], v[160:175]
  ds_read_b32 v49, v5 offset:9360
  ds_read_b32 v50, v5 offset:10400
  ds_read_b32 v51, v5 offset:11440
  ds_read_b32 v52, v5 offset:12480
  s_waitcnt lgkmcnt(14)
  ds_read_b32 v53, v5 offset:13520
  v_mfma_f32_32x32x16_bf16 v[176:191], a[24:27], v[36:39], v[176:191]
  s_waitcnt lgkmcnt(14)
  ds_read_b32 v54, v5 offset:14560
  s_waitcnt lgkmcnt(14)
  ds_read_b32 v55, v5 offset:15600
  s_waitcnt vmcnt(0)
  v_lshlrev_b32 v56, 16, v22
  v_and_b32 v57, v11, v22
  s_waitcnt lgkmcnt(9)
  v_mul_f32 v48, v48, v56
  ds_read_b64_tr_b16 v[36:37], v2 offset:2720
  ds_read_b64_tr_b16 v[38:39], v2 offset:2688
  v_mfma_f32_32x32x16_bf16 v[160:175], a[4:7], v[40:43], v[160:175]
  s_waitcnt lgkmcnt(8)
  v_mul_f32 v49, v49, v57
  v_cvt_pk_bf16_f32 v58, v48, v49
  v_lshlrev_b32 v56, 16, v23
  v_and_b32 v57, v11, v23
  s_waitcnt lgkmcnt(7)
  v_mul_f32 v50, v50, v56
  v_mfma_f32_32x32x16_bf16 v[176:191], a[20:23], v[40:43], v[176:191]
  s_waitcnt lgkmcnt(6)
  v_mul_f32 v51, v51, v57
  v_cvt_pk_bf16_f32 v59, v50, v51
  v_lshlrev_b32 v56, 16, v24
  v_and_b32 v57, v11, v24
  ds_read_b64_tr_b16 v[40:41], v2 offset:2848
  ds_read_b64_tr_b16 v[42:43], v2 offset:2816
  v_mfma_f32_32x32x16_bf16 v[160:175], a[0:3], v[44:47], v[160:175]
  s_waitcnt lgkmcnt(7)
  v_mul_f32 v52, v52, v56
  s_waitcnt lgkmcnt(6)
  v_mul_f32 v53, v53, v57
  v_cvt_pk_bf16_f32 v60, v52, v53
  v_lshlrev_b32 v56, 16, v25
  v_and_b32 v57, v11, v25
  v_mfma_f32_32x32x16_bf16 v[176:191], a[16:19], v[44:47], v[176:191]
  s_waitcnt lgkmcnt(5)
  v_mul_f32 v54, v54, v56
  s_waitcnt lgkmcnt(4)
  v_mul_f32 v55, v55, v57
  v_cvt_pk_bf16_f32 v61, v54, v55
  s_mov_b32 s46, 2621440
  buffer_store_dwordx4 v[58:61], v10, s[12:15], s46 offen
  s_nop 1
  s_barrier
  s_setprio 0
  ds_read_b64_tr_b16 v[44:45], v2 offset:2976
  ds_read_b64_tr_b16 v[46:47], v2 offset:2944
  v_mfma_f32_32x32x16_bf16 v[176:191], a[44:47], v[32:35], v[176:191]
  v_add_f32_dpp v28, v159, v162 wave_ror:1 row_mask:0x1 bank_mask:0x1
  v_add_f32_dpp v28, v163, v162 wave_shr:1 row_mask:0xf bank_mask:0xf
  v_add_f32_dpp v29, v163, v166 wave_ror:1 row_mask:0x1 bank_mask:0x1
  v_add_f32_dpp v29, v167, v166 wave_shr:1 row_mask:0xf bank_mask:0xf
  v_add_f32_dpp v30, v167, v170 wave_ror:1 row_mask:0x1 bank_mask:0x1
  v_add_f32_dpp v30, v171, v170 wave_shr:1 row_mask:0xf bank_mask:0xf
  v_add_f32_dpp v26, v171, v174 wave_ror:1 row_mask:0x1 bank_mask:0x1
  v_add_f32_dpp v26, v175, v174 wave_shr:1 row_mask:0xf bank_mask:0xf
  ds_read_b64_tr_b16 v[32:33], v2 offset:3616
  ds_read_b64_tr_b16 v[34:35], v2 offset:3584
  s_waitcnt lgkmcnt(6)
  v_mfma_f32_32x32x16_bf16 v[176:191], a[40:43], v[36:39], v[176:191]
  v_add_f32_dpp v162, v27, v161 wave_ror:1 row_mask:0x1 bank_mask:0x1
  v_add_f32_dpp v162, v28, v161 wave_shr:1 row_mask:0xf bank_mask:0xf
  v_add_f32_dpp v166, v28, v165 wave_ror:1 row_mask:0x1 bank_mask:0x1
  v_add_f32_dpp v166, v29, v165 wave_shr:1 row_mask:0xf bank_mask:0xf
  v_add_f32_dpp v170, v29, v169 wave_ror:1 row_mask:0x1 bank_mask:0x1
  v_add_f32_dpp v170, v30, v169 wave_shr:1 row_mask:0xf bank_mask:0xf
  ds_read_b64_tr_b16 v[36:37], v2 offset:3744
  ds_read_b64_tr_b16 v[38:39], v2 offset:3712
  s_waitcnt lgkmcnt(6)
  v_mfma_f32_32x32x16_bf16 v[176:191], a[36:39], v[40:43], v[176:191]
  v_add_f32_dpp v174, v30, v173 wave_ror:1 row_mask:0x1 bank_mask:0x1
  v_add_f32_dpp v174, v26, v173 wave_shr:1 row_mask:0xf bank_mask:0xf
  v_add_f32_dpp v161, v158, v160 wave_ror:1 row_mask:0x1 bank_mask:0x1
  v_add_f32_dpp v161, v162, v160 wave_shr:1 row_mask:0xf bank_mask:0xf
  v_add_f32_dpp v165, v162, v164 wave_ror:1 row_mask:0x1 bank_mask:0x1
  v_add_f32_dpp v165, v166, v164 wave_shr:1 row_mask:0xf bank_mask:0xf
  v_add_f32_dpp v169, v166, v168 wave_ror:1 row_mask:0x1 bank_mask:0x1
  v_add_f32_dpp v169, v170, v168 wave_shr:1 row_mask:0xf bank_mask:0xf
  ds_read_b64_tr_b16 v[40:41], v2 offset:3872
  ds_read_b64_tr_b16 v[42:43], v2 offset:3840
  s_waitcnt lgkmcnt(6)
  v_mfma_f32_32x32x16_bf16 v[176:191], a[32:35], v[44:47], v[176:191]
  v_add_f32_dpp v173, v170, v172 wave_ror:1 row_mask:0x1 bank_mask:0x1
  v_add_f32_dpp v173, v174, v172 wave_shr:1 row_mask:0xf bank_mask:0xf
  s_mov_b32 m0, s47
  s_nop 0
  ds_write_addtid_b32 v161 offset:0
  ds_write_addtid_b32 v165 offset:256
  ds_write_addtid_b32 v169 offset:512
  ds_write_addtid_b32 v173 offset:768
  s_mov_b32 s46, 1966080
  buffer_load_dwordx4 v[22:25], v9, s[8:11], s46 offen
  ds_read_b64_tr_b16 v[44:45], v2 offset:4000
  ds_read_b64_tr_b16 v[46:47], v2 offset:3968
  s_waitcnt lgkmcnt(10)
  v_mfma_f32_32x32x16_bf16 v[176:191], a[12:15], v[32:35], v[176:191]
  s_waitcnt lgkmcnt(8)
  v_mfma_f32_32x32x16_bf16 v[176:191], a[8:11], v[36:39], v[176:191]
  s_waitcnt lgkmcnt(6)
  v_mfma_f32_32x32x16_bf16 v[176:191], a[4:7], v[40:43], v[176:191]
  s_waitcnt lgkmcnt(0)
  v_mfma_f32_32x32x16_bf16 v[176:191], a[0:3], v[44:47], v[176:191]
  s_nop 11
  v_add_f32_dpp v28, v175, v178 wave_ror:1 row_mask:0x1 bank_mask:0x1
  s_nop 10
  v_add_f32_dpp v28, v179, v178 wave_shr:1 row_mask:0xf bank_mask:0xf
  s_nop 9
  v_add_f32_dpp v29, v179, v182 wave_ror:1 row_mask:0x1 bank_mask:0x1
  s_nop 8
  v_add_f32_dpp v29, v183, v182 wave_shr:1 row_mask:0xf bank_mask:0xf
  s_nop 7
  v_add_f32_dpp v30, v183, v186 wave_ror:1 row_mask:0x1 bank_mask:0x1
  s_nop 6
  v_add_f32_dpp v30, v187, v186 wave_shr:1 row_mask:0xf bank_mask:0xf
  s_nop 5
  v_add_f32_dpp v27, v187, v190 wave_ror:1 row_mask:0x1 bank_mask:0x1
  s_nop 4
  v_add_f32_dpp v27, v191, v190 wave_shr:1 row_mask:0xf bank_mask:0xf
  s_nop 3
  v_add_f32_dpp v178, v26, v177 wave_ror:1 row_mask:0x1 bank_mask:0x1
  s_nop 2
  v_add_f32_dpp v178, v28, v177 wave_shr:1 row_mask:0xf bank_mask:0xf
  s_nop 1
  v_add_f32_dpp v182, v28, v181 wave_ror:1 row_mask:0x1 bank_mask:0x1
  s_nop 0
  v_add_f32_dpp v182, v29, v181 wave_shr:1 row_mask:0xf bank_mask:0xf
  v_add_f32_dpp v186, v29, v185 wave_ror:1 row_mask:0x1 bank_mask:0x1
  v_add_f32_dpp v186, v30, v185 wave_shr:1 row_mask:0xf bank_mask:0xf
  v_add_f32_dpp v190, v30, v189 wave_ror:1 row_mask:0x1 bank_mask:0x1
  v_add_f32_dpp v190, v27, v189 wave_shr:1 row_mask:0xf bank_mask:0xf
  v_add_f32_dpp v177, v174, v176 wave_ror:1 row_mask:0x1 bank_mask:0x1
  v_add_f32_dpp v177, v178, v176 wave_shr:1 row_mask:0xf bank_mask:0xf
  v_add_f32_dpp v181, v178, v180 wave_ror:1 row_mask:0x1 bank_mask:0x1
  v_add_f32_dpp v181, v182, v180 wave_shr:1 row_mask:0xf bank_mask:0xf
  v_add_f32_dpp v185, v182, v184 wave_ror:1 row_mask:0x1 bank_mask:0x1
  v_add_f32_dpp v185, v186, v184 wave_shr:1 row_mask:0xf bank_mask:0xf
  v_add_f32_dpp v189, v186, v188 wave_ror:1 row_mask:0x1 bank_mask:0x1
  v_add_f32_dpp v189, v190, v188 wave_shr:1 row_mask:0xf bank_mask:0xf
  s_mov_b32 m0, s47
  s_nop 0
  ds_write_addtid_b32 v177 offset:8320
  ds_write_addtid_b32 v181 offset:8576
  ds_write_addtid_b32 v185 offset:8832
  ds_write_addtid_b32 v189 offset:9088
  s_waitcnt lgkmcnt(0)
  s_barrier
  s_setprio 0
  ds_read_b32 v48, v5 offset:0
  ds_read_b32 v49, v5 offset:1040
  ds_read_b32 v50, v5 offset:2080
  ds_read_b32 v51, v5 offset:3120
  ds_read_b32 v52, v5 offset:4160
  ds_read_b32 v53, v5 offset:5200
  ds_read_b32 v54, v5 offset:6240
  ds_read_b32 v55, v5 offset:7280
  s_waitcnt vmcnt(0)
  v_lshlrev_b32 v56, 16, v22
  v_and_b32 v57, v11, v22
  s_waitcnt lgkmcnt(7)
  v_mul_f32 v48, v48, v56
  s_waitcnt lgkmcnt(6)
  v_mul_f32 v49, v49, v57
  v_cvt_pk_bf16_f32 v58, v48, v49
  v_lshlrev_b32 v56, 16, v23
  v_and_b32 v57, v11, v23
  s_waitcnt lgkmcnt(5)
  v_mul_f32 v50, v50, v56
  s_waitcnt lgkmcnt(4)
  v_mul_f32 v51, v51, v57
  v_cvt_pk_bf16_f32 v59, v50, v51
  v_lshlrev_b32 v56, 16, v24
  v_and_b32 v57, v11, v24
  s_waitcnt lgkmcnt(3)
  v_mul_f32 v52, v52, v56
  s_waitcnt lgkmcnt(2)
  v_mul_f32 v53, v53, v57
  v_cvt_pk_bf16_f32 v60, v52, v53
  v_lshlrev_b32 v56, 16, v25
  v_and_b32 v57, v11, v25
  s_waitcnt lgkmcnt(1)
  v_mul_f32 v54, v54, v56
  s_waitcnt lgkmcnt(0)
  v_mul_f32 v55, v55, v57
  v_cvt_pk_bf16_f32 v61, v54, v55
  s_mov_b32 s46, 3932160
  buffer_store_dwordx4 v[58:61], v10, s[12:15], s46 offen
  s_nop 1
  s_branch L_END
L_A:
  s_mul_i32 s3, s6, 20
  s_add_u32 s3, s3, s7
  s_sub_u32 s3, s3, 10
  s_lshl_b32 s5, s3, 2
  s_load_dwordx4 s[52:55], s[0:1], 0
  s_load_dwordx4 s[56:59], s[0:1], 16
  s_load_dwordx4 s[60:63], s[0:1], 32
  s_load_dwordx2 s[64:65], s[0:1], 48
  s_load_dwordx2 s[66:67], s[0:1], 104
  s_load_dwordx4 s[84:87], s[0:1], 56
  s_load_dwordx2 s[88:89], s[0:1], 72
  s_load_dwordx2 s[28:29], s[0:1], 88
  v_and_b32 v1, 63, v0
  v_mov_b32 v11, 0xffff0000
  s_add_u32 s7, s5, s45
  s_waitcnt lgkmcnt(0)
  s_mul_i32 s46, s7, 384
  s_lshl_b32 s48, s44, 6
  v_add_u32 v32, s48, v1
  v_lshlrev_b32 v32, 1, v32
  v_add_u32 v33, 128, v1
  v_lshlrev_b32 v33, 1, v33
  s_mov_b32 s8, s54
  s_and_b32 s9, s55, 0xffff
  s_mov_b32 s10, 245760
  s_mov_b32 s11, 0x20000
  s_mov_b32 s12, s56
  s_and_b32 s13, s57, 0xffff
  s_mov_b32 s14, 245760
  s_mov_b32 s15, 0x20000
  s_mov_b32 s16, s58
  s_and_b32 s17, s59, 0xffff
  s_mov_b32 s18, 245760
  s_mov_b32 s19, 0x20000
  s_mov_b32 s20, s60
  s_and_b32 s21, s61, 0xffff
  s_mov_b32 s22, 245760
  s_mov_b32 s23, 0x20000
  buffer_load_ushort v40, v32, s[8:11], s46 offen
  buffer_load_ushort v41, v32, s[12:15], s46 offen
  buffer_load_ushort v42, v32, s[16:19], s46 offen
  buffer_load_ushort v43, v32, s[20:23], s46 offen
  buffer_load_ushort v44, v33, s[8:11], s46 offen
  buffer_load_ushort v45, v33, s[12:15], s46 offen
  buffer_load_ushort v46, v33, s[16:19], s46 offen
  buffer_load_ushort v47, v33, s[20:23], s46 offen
  s_barrier
  s_lshl_b32 s48, s7, 1
  s_and_b32 s48, s48, 0xfffffffc
  s_load_dword s36, s[62:63], s48
  s_load_dword s37, s[64:65], s48
  s_lshr_b32 s35, s2, 3
  s_sub_u32 s35, s35, 10
  s_lshl_b32 s35, s35, 2
  s_add_u32 s35, s35, s45
  v_lshrrev_b32 v34, 1, v1
  v_mul_u32_u24 v34, 1280, v34
  v_and_b32 v35, 1, v1
  v_lshlrev_b32 v35, 7, v35
  v_add_u32 v34, v34, v35
  s_mul_i32 s48, s6, 160
  s_and_b32 s48, s48, 0xffffff80
  v_add_u32 v62, s48, v34
  v_lshlrev_b32 v61, 7, v1
  s_cmp_eq_u32 s44, 0
  s_cbranch_scc0 L_pt2827b
  s_mov_b32 s16, s52
  s_mov_b32 s17, s53
  s_mov_b32 s48, 2621440
  s_mov_b32 s27, 0
  s_sub_u32 s49, s35, 0
  s_mov_b32 s24, s28
  s_mov_b32 s25, s29
  s_mul_i32 s26, s6, 327680
  s_lshl_b32 s31, s49, 13
  s_add_u32 s26, s26, s31
  s_cmp_lt_u32 s49, 40
  s_cselect_b32 s16, s24, s16
  s_cselect_b32 s17, s25, s17
  s_cselect_b32 s48, s26, s48
  s_cselect_b32 s27, 1, s27
  s_sub_u32 s49, s35, 40
  s_and_b32 s31, s49, 1
  s_cmp_eq_u32 s31, 0
  s_cselect_b32 s24, s86, s88
  s_cselect_b32 s25, s87, s89
  s_lshr_b32 s26, s49, 1
  s_add_u32 s26, s26, 8
  s_mul_i32 s26, s26, 40960
  s_cmp_lt_u32 s49, 32
  s_cselect_b32 s16, s24, s16
  s_cselect_b32 s17, s25, s17
  s_cselect_b32 s48, s26, s48
  s_sub_u32 s49, s35, 72
  s_mov_b32 s24, s52
  s_mov_b32 s25, s53
  s_add_u32 s26, s49, 0
  s_mul_i32 s26, s26, 40960
  s_cmp_lt_u32 s49, 8
  s_cselect_b32 s16, s24, s16
  s_cselect_b32 s17, s25, s17
  s_cselect_b32 s48, s26, s48
  s_and_b32 s17, s17, 0xffff
  s_mov_b32 s18, 2621440
  s_mov_b32 s19, 0x20000
  s_cmp_eq_u32 s27, 0
  s_cbranch_scc1 L_pf2868a
  buffer_load_dword v56, v61, s[16:19], s48 offen
  s_branch L_pf2868b
L_pf2868a:
  buffer_load_dword v56, v62, s[16:19], s48 offen
L_pf2868b:
  s_branch L_pt2827e
L_pt2827b:
L_pt2827e:
  s_cmp_eq_u32 s44, 0
  s_cbranch_scc0 L_pt2878b
  s_branch L_pt2878e
L_pt2878b:
  s_mov_b32 s16, s52
  s_mov_b32 s17, s53
  s_mov_b32 s48, 2621440
  s_mov_b32 s27, 0
  s_sub_u32 s49, s35, 0
  s_mov_b32 s24, s52
  s_mov_b32 s25, s53
  s_add_u32 s26, s49, 8
  s_mul_i32 s26, s26, 40960
  s_cmp_lt_u32 s49, 24
  s_cselect_b32 s16, s24, s16
  s_cselect_b32 s17, s25, s17
  s_cselect_b32 s48, s26, s48
  s_sub_u32 s49, s35, 24
  s_and_b32 s31, s49, 1
  s_cmp_eq_u32 s31, 0
  s_cselect_b32 s24, s86, s88
  s_cselect_b32 s25, s87, s89
  s_lshr_b32 s26, s49, 1
  s_add_u32 s26, s26, 24
  s_mul_i32 s26, s26, 40960
  s_cmp_lt_u32 s49, 56
  s_cselect_b32 s16, s24, s16
  s_cselect_b32 s17, s25, s17
  s_cselect_b32 s48, s26, s48
  s_and_b32 s17, s17, 0xffff
  s_mov_b32 s18, 2621440
  s_mov_b32 s19, 0x20000
  buffer_load_dword v58, v62, s[16:19], s48 offen
L_pt2878e:
  s_mov_b32 s8, s52
  s_and_b32 s9, s53, 0xffff
  s_mov_b32 s10, 2621440
  s_mov_b32 s11, 0x20000
  s_mov_b32 s12, s66
  s_and_b32 s13, s67, 0xffff
  s_mov_b32 s14, 5242880
  s_mov_b32 s15, 0x20000
  s_mov_b32 s38, s4
  s_lshl_b32 s48, s5, 1
  v_mul_u32_u24 v63, 5120, v1
  v_add_u32 v63, s48, v63
  s_mul_i32 s39, s4, 16048
  v_lshlrev_b32 v32, 2, v1
  v_add_u32 v12, s39, v32
  v_and_b32 v32, 31, v1
  v_mov_b32 v33, v32
  v_cmp_lt_u32 vcc, 7, v32
  v_subrev_u32 v34, 1, v33
  s_nop 0
  v_cndmask_b32 v33, v33, v34, vcc
  v_cmp_lt_u32 vcc, 15, v32
  v_subrev_u32 v34, 1, v33
  s_nop 0
  v_cndmask_b32 v33, v33, v34, vcc
  v_cmp_lt_u32 vcc, 27, v32
  v_subrev_u32 v34, 3, v33
  s_nop 0
  v_cndmask_b32 v33, v33, v34, vcc
  v_mul_u32_u24 v33, 272, v33
  v_bfe_u32 v34, v1, 5, 1
  v_lshlrev_b32 v34, 4, v34
  v_add_u32 v33, v33, v34
  v_add_u32 v13, s39, v33
  v_add_u32 v32, 27, v32
  v_mul_u32_u24 v32, 272, v32
  v_add_u32 v32, v32, v34
  v_add_u32 v15, s39, v32
  s_mul_i32 s48, s45, 4176
  s_add_u32 s24, s48, 128384
  s_mul_i32 s25, s45, 16048
  v_bfe_u32 v32, v1, 4, 1
  v_lshlrev_b32 v32, 5, v32
  v_bfe_u32 v33, v1, 5, 1
  v_lshlrev_b32 v33, 6, v33
  v_sub_u32 v32, v32, v33
  v_bfe_u32 v33, v1, 2, 2
  v_lshlrev_b32 v33, 3, v33
  v_sub_u32 v32, v32, v33
  v_and_b32 v33, 3, v1
  v_lshlrev_b32 v33, 3, v33
  v_add_u32 v32, v32, v33
  v_add_u32 v32, 96, v32
  v_add_u32 v2, s24, v32
  v_and_b32 v32, 3, v1
  v_mul_u32_u24 v32, 1216, v32
  v_bfe_u32 v33, v1, 2, 3
  v_bfe_u32 v34, v1, 5, 1
  v_add_u32 v33, v33, v34
  v_lshlrev_b32 v33, 4, v33
  v_add_u32 v32, v32, v33
  v_add_u32 v3, s25, v32
  v_lshlrev_b32 v32, 2, v1
  v_add_u32 v36, s25, v32
  v_add_u32 v33, s24, v32
  v_mov_b32 v34, 0
  s_mov_b64 exec, 0xffff
  ds_write_b32 v33, v34
  s_mov_b64 exec, -1
  s_mul_i32 s48, s45, 1040
  s_add_u32 s48, s48, 66560
  v_add_u32 v4, s48, v32
  s_mov_b32 s47, s48
  s_lshl_b32 s48, s45, 8
  s_add_u32 s48, s48, 66560
  v_add_u32 v5, s48, v32
  v_add_u32 v6, 67584, v32
  s_lshl_b32 s48, s45, 6
  v_add_u32 v32, s48, v1
  v_mul_u32_u24 v33, 2560, v32
  s_lshl_b32 s48, s5, 1
  v_add_u32 v10, s48, v33
  v_lshlrev_b32 v32, 4, v1
  s_mul_i32 s48, s45, 16048
  s_add_u32 s49, s48, 64192
  s_add_u32 s48, s48, 7344
  s_cmp_eq_u32 s44, 0
  s_cselect_b32 s26, s48, s49
  s_cselect_b32 s27, s49, s48
  v_add_u32 v7, s26, v32
  v_add_u32 v8, s27, v32
  v_and_b32 v18, 31, v1
  v_lshlrev_b32 v18, 2, v18
  v_add_u32 v18, s25, v18
  v_lshlrev_b32 v9, 3, v1
  s_lshl_b32 s48, s38, 9
  s_add_u32 s48, s48, 128448
  v_add_u32 v9, s48, v9
  v_and_b32 v14, 1, v1
  v_mul_u32_u24 v14, 0x0202, v14
  v_lshlrev_b32 v14, 16, v14
  v_add_u32 v14, 0x01000100, v14
  s_mul_i32 s34, s38, 327680
  s_mov_b32 s32, 0x05040100
  s_mov_b32 s33, 0x07060302
  s_cmp_eq_u32 s45, 0
  s_cselect_b32 s38, 1.0, 0
  s_waitcnt lgkmcnt(0)
  s_and_b32 s48, s7, 1
  s_lshl_b32 s48, s48, 4
  s_lshr_b32 s36, s36, s48
  s_lshl_b32 s36, s36, 16
  s_lshr_b32 s37, s37, s48
  s_lshl_b32 s37, s37, 16
  v_mov_b32 v16, s36
  v_mul_f32 v16, 0x3fb8aa3b, v16
  v_exp_f32 v16, v16
  s_nop 0
  v_cvt_pk_bf16_f32 v16, v16, v16
  v_and_b32 v16, v11, v16
  v_add_f32 v17, v16, v16
  s_cmp_eq_u32 s44, 0
  s_cbranch_scc0 L_pt3033b
  s_waitcnt vmcnt(1)
  s_branch L_pt3033e
L_pt3033b:
  s_waitcnt vmcnt(1)
L_pt3033e:
  v_mov_b32 v19, v12
  v_add_u32 v20, 1088, v12
  v_add_u32 v21, 1904, v12
  v_add_u32 v22, 2992, v12
  v_add_u32 v23, 3808, v12
  v_add_u32 v24, 4896, v12
  v_add_u32 v25, 6256, v12
  v_add_u32 v26, 7344, v12
  v_add_u32 v27, 8432, v12
  v_add_u32 v28, 9520, v12
  v_add_u32 v29, 10608, v12
  v_add_u32 v30, 11696, v12
  v_add_u32 v31, 12784, v12
  v_add_u32 v118, 13872, v12
  v_add_u32 v119, 14960, v12
  s_cmp_eq_u32 s44, 0
  s_cbranch_scc0 L_pt3055b
  s_setprio 0
  s_branch L_pt3055e
L_pt3055b:
  s_setprio 1
L_pt3055e:
  v_lshlrev_b32 v114, 16, v40
  v_lshlrev_b32 v115, 16, v41
  v_lshlrev_b32 v116, 16, v42
  v_lshlrev_b32 v117, 16, v43
  v_mul_f32 v32, 0x3fb8aa3b, v114
  v_mul_f32 v33, v115, v16
  v_exp_f32 v32, v32
  v_mul_f32 v33, 0.15915494, v33
  v_mul_f32 v92, v116, v17
  v_cvt_pk_bf16_f32 v32, v32, v32
  v_fract_f32 v33, v33
  v_and_b32 v32, v11, v32
  v_mul_f32 v93, v117, v17
  v_mul_f32 v32, v32, v16
  v_cos_f32 v34, v33
  v_mul_f32 v32, 0xbfb8aa3b, v32
  v_sin_f32 v35, v33
  v_exp_f32 v32, v32
  v_cvt_pk_bf16_f32 v184, v92, -v93
  v_mul_f32 v80, v32, v34
  v_mul_f32 v81, v32, v35
  v_mov_b32 v185, 0x3f80
  v_pk_mul_f32 v[82:83], v[80:81], v[80:81] op_sel_hi:[1,0]
  v_pk_mul_f32 v[94:95], v[92:93], v[80:81] op_sel_hi:[1,0]
  v_pk_fma_f32 v[82:83], v[80:81], v[80:81], v[82:83] op_sel:[1,1,0] op_sel_hi:[0,1,1] neg_lo:[0,1,0]
  v_pk_fma_f32 v[94:95], v[92:93], v[80:81], v[94:95] op_sel:[1,1,0] op_sel_hi:[0,1,1] neg_lo:[0,1,0]
  v_cvt_pk_bf16_f32 v186, v94, -v95
  ds_write2_b32 v19, v186, v184 offset0:68 offset1:0
  v_pk_mul_f32 v[84:85], v[82:83], v[82:83] op_sel_hi:[1,0]
  v_pk_mul_f32 v[96:97], v[94:95], v[80:81] op_sel_hi:[1,0]
  v_pk_fma_f32 v[84:85], v[82:83], v[82:83], v[84:85] op_sel:[1,1,0] op_sel_hi:[0,1,1] neg_lo:[0,1,0]
  v_pk_fma_f32 v[96:97], v[94:95], v[80:81], v[96:97] op_sel:[1,1,0] op_sel_hi:[0,1,1] neg_lo:[0,1,0]
  v_cvt_pk_bf16_f32 v187, v96, -v97
  v_pk_mul_f32 v[86:87], v[84:85], v[84:85] op_sel_hi:[1,0]
  v_pk_mul_f32 v[98:99], v[96:97], v[80:81] op_sel_hi:[1,0]
  v_pk_fma_f32 v[86:87], v[84:85], v[84:85], v[86:87] op_sel:[1,1,0] op_sel_hi:[0,1,1] neg_lo:[0,1,0]
  v_pk_fma_f32 v[98:99], v[96:97], v[80:81], v[98:99] op_sel:[1,1,0] op_sel_hi:[0,1,1] neg_lo:[0,1,0]
  v_cvt_pk_bf16_f32 v188, v86, v87
  ds_write2_b32 v26, v188, v185 offset0:68 offset1:0
  v_cvt_pk_bf16_f32 v189, v98, -v99
  ds_write2_b32 v19, v189, v187 offset0:204 offset1:136
  v_pk_mul_f32 v[88:89], v[86:87], v[86:87] op_sel_hi:[1,0]
  v_pk_mul_f32 v[94:95], v[98:99], v[80:81] op_sel_hi:[1,0]
  v_pk_fma_f32 v[88:89], v[86:87], v[86:87], v[88:89] op_sel:[1,1,0] op_sel_hi:[0,1,1] neg_lo:[0,1,0]
  v_pk_fma_f32 v[94:95], v[98:99], v[80:81], v[94:95] op_sel:[1,1,0] op_sel_hi:[0,1,1] neg_lo:[0,1,0]
  v_cvt_pk_bf16_f32 v190, v94, -v95
  v_pk_mul_f32 v[104:105], v[86:87], v[88:89] op_sel_hi:[1,0]
  v_pk_mul_f32 v[96:97], v[94:95], v[80:81] op_sel_hi:[1,0]
  v_pk_fma_f32 v[104:105], v[86:87], v[88:89], v[104:105] op_sel:[1,1,0] op_sel_hi:[0,1,1] neg_lo:[0,1,0]
  v_pk_fma_f32 v[96:97], v[94:95], v[80:81], v[96:97] op_sel:[1,1,0] op_sel_hi:[0,1,1] neg_lo:[0,1,0]
  v_cvt_pk_bf16_f32 v191, v88, v89
  v_cvt_pk_bf16_f32 v186, v104, v105
  ds_write2_b32 v26, v186, v191 offset0:204 offset1:136
  v_cvt_pk_bf16_f32 v184, v96, -v97
  ds_write2_b32 v21, v184, v190 offset0:68 offset1:0
  v_pk_mul_f32 v[100:101], v[88:89], v[88:89] op_sel_hi:[1,0]
  v_pk_mul_f32 v[106:107], v[104:105], v[88:89] op_sel_hi:[1,0]
  v_pk_mul_f32 v[98:99], v[96:97], v[80:81] op_sel_hi:[1,0]
  v_pk_fma_f32 v[100:101], v[88:89], v[88:89], v[100:101] op_sel:[1,1,0] op_sel_hi:[0,1,1] neg_lo:[0,1,0]
  v_pk_fma_f32 v[106:107], v[104:105], v[88:89], v[106:107] op_sel:[1,1,0] op_sel_hi:[0,1,1] neg_lo:[0,1,0]
  v_pk_fma_f32 v[98:99], v[96:97], v[80:81], v[98:99] op_sel:[1,1,0] op_sel_hi:[0,1,1] neg_lo:[0,1,0]
  v_cvt_pk_bf16_f32 v188, v100, v101
  v_cvt_pk_bf16_f32 v185, v106, v107
  ds_write2_b32 v27, v185, v188 offset0:68 offset1:0
  v_cvt_pk_bf16_f32 v189, v98, -v99
  v_pk_mul_f32 v[102:103], v[100:101], v[88:89] op_sel_hi:[1,0]
  v_pk_mul_f32 v[104:105], v[106:107], v[88:89] op_sel_hi:[1,0]
  v_pk_mul_f32 v[94:95], v[98:99], v[80:81] op_sel_hi:[1,0]
  v_pk_fma_f32 v[102:103], v[100:101], v[88:89], v[102:103] op_sel:[1,1,0] op_sel_hi:[0,1,1] neg_lo:[0,1,0]
  v_pk_fma_f32 v[104:105], v[106:107], v[88:89], v[104:105] op_sel:[1,1,0] op_sel_hi:[0,1,1] neg_lo:[0,1,0]
  v_pk_fma_f32 v[94:95], v[98:99], v[80:81], v[94:95] op_sel:[1,1,0] op_sel_hi:[0,1,1] neg_lo:[0,1,0]
  v_cvt_pk_bf16_f32 v187, v102, v103
  v_cvt_pk_bf16_f32 v186, v104, v105
  ds_write2_b32 v27, v186, v187 offset0:204 offset1:136
  v_cvt_pk_bf16_f32 v191, v94, -v95
  ds_write2_b32 v21, v191, v189 offset0:204 offset1:136
  v_pk_mul_f32 v[100:101], v[102:103], v[88:89] op_sel_hi:[1,0]
  v_pk_mul_f32 v[106:107], v[104:105], v[88:89] op_sel_hi:[1,0]
  v_pk_fma_f32 v[100:101], v[102:103], v[88:89], v[100:101] op_sel:[1,1,0] op_sel_hi:[0,1,1] neg_lo:[0,1,0]
  v_pk_fma_f32 v[106:107], v[104:105], v[88:89], v[106:107] op_sel:[1,1,0] op_sel_hi:[0,1,1] neg_lo:[0,1,0]
  v_cvt_pk_bf16_f32 v184, v100, v101
  v_cvt_pk_bf16_f32 v190, v106, v107
  ds_write2_b32 v28, v190, v184 offset0:68 offset1:0
  v_pk_mul_f32 v[102:103], v[100:101], v[88:89] op_sel_hi:[1,0]
  v_pk_mul_f32 v[104:105], v[106:107], v[88:89] op_sel_hi:[1,0]
  v_pk_fma_f32 v[102:103], v[100:101], v[88:89], v[102:103] op_sel:[1,1,0] op_sel_hi:[0,1,1] neg_lo:[0,1,0]
  v_pk_fma_f32 v[104:105], v[106:107], v[88:89], v[104:105] op_sel:[1,1,0] op_sel_hi:[0,1,1] neg_lo:[0,1,0]
  v_cvt_pk_bf16_f32 v185, v102, v103
  v_cvt_pk_bf16_f32 v188, v104, v105
  ds_write2_b32 v28, v188, v185 offset0:204 offset1:136
  v_pk_mul_f32 v[100:101], v[102:103], v[88:89] op_sel_hi:[1,0]
  v_pk_mul_f32 v[106:107], v[104:105], v[88:89] op_sel_hi:[1,0]
  v_pk_fma_f32 v[100:101], v[102:103], v[88:89], v[100:101] op_sel:[1,1,0] op_sel_hi:[0,1,1] neg_lo:[0,1,0]
  v_pk_fma_f32 v[106:107], v[104:105], v[88:89], v[106:107] op_sel:[1,1,0] op_sel_hi:[0,1,1] neg_lo:[0,1,0]
  v_cvt_pk_bf16_f32 v186, v100, v101
  v_cvt_pk_bf16_f32 v187, v106, v107
  ds_write2_b32 v29, v187, v186 offset0:68 offset1:0
  v_pk_mul_f32 v[102:103], v[100:101], v[88:89] op_sel_hi:[1,0]
  v_pk_mul_f32 v[104:105], v[106:107], v[88:89] op_sel_hi:[1,0]
  v_pk_fma_f32 v[102:103], v[100:101], v[88:89], v[102:103] op_sel:[1,1,0] op_sel_hi:[0,1,1] neg_lo:[0,1,0]
  v_pk_fma_f32 v[104:105], v[106:107], v[88:89], v[104:105] op_sel:[1,1,0] op_sel_hi:[0,1,1] neg_lo:[0,1,0]
  v_cvt_pk_bf16_f32 v191, v102, v103
  v_cvt_pk_bf16_f32 v189, v104, v105
  ds_write2_b32 v29, v189, v191 offset0:204 offset1:136
  v_pk_mul_f32 v[100:101], v[102:103], v[88:89] op_sel_hi:[1,0]
  v_pk_mul_f32 v[106:107], v[104:105], v[88:89] op_sel_hi:[1,0]
  v_pk_fma_f32 v[100:101], v[102:103], v[88:89], v[100:101] op_sel:[1,1,0] op_sel_hi:[0,1,1] neg_lo:[0,1,0]
  v_pk_fma_f32 v[106:107], v[104:105], v[88:89], v[106:107] op_sel:[1,1,0] op_sel_hi:[0,1,1] neg_lo:[0,1,0]
  v_cvt_pk_bf16_f32 v190, v100, v101
  v_cvt_pk_bf16_f32 v184, v106, v107
  ds_write2_b32 v30, v184, v190 offset0:68 offset1:0
  v_pk_mul_f32 v[102:103], v[100:101], v[88:89] op_sel_hi:[1,0]
  v_pk_mul_f32 v[104:105], v[106:107], v[88:89] op_sel_hi:[1,0]
  v_pk_fma_f32 v[102:103], v[100:101], v[88:89], v[102:103] op_sel:[1,1,0] op_sel_hi:[0,1,1] neg_lo:[0,1,0]
  v_pk_fma_f32 v[104:105], v[106:107], v[88:89], v[104:105] op_sel:[1,1,0] op_sel_hi:[0,1,1] neg_lo:[0,1,0]
  v_cvt_pk_bf16_f32 v188, v102, v103
  v_cvt_pk_bf16_f32 v185, v104, v105
  ds_write2_b32 v30, v185, v188 offset0:204 offset1:136
  v_pk_mul_f32 v[100:101], v[102:103], v[88:89] op_sel_hi:[1,0]
  v_pk_mul_f32 v[106:107], v[104:105], v[88:89] op_sel_hi:[1,0]
  v_pk_fma_f32 v[100:101], v[102:103], v[88:89], v[100:101] op_sel:[1,1,0] op_sel_hi:[0,1,1] neg_lo:[0,1,0]
  v_pk_fma_f32 v[106:107], v[104:105], v[88:89], v[106:107] op_sel:[1,1,0] op_sel_hi:[0,1,1] neg_lo:[0,1,0]
  v_cvt_pk_bf16_f32 v187, v100, v101
  v_cvt_pk_bf16_f32 v186, v106, v107
  ds_write2_b32 v31, v186, v187 offset0:68 offset1:0
  v_pk_mul_f32 v[102:103], v[100:101], v[88:89] op_sel_hi:[1,0]
  v_pk_mul_f32 v[104:105], v[106:107], v[88:89] op_sel_hi:[1,0]
  v_pk_fma_f32 v[102:103], v[100:101], v[88:89], v[102:103] op_sel:[1,1,0] op_sel_hi:[0,1,1] neg_lo:[0,1,0]
  v_pk_fma_f32 v[104:105], v[106:107], v[88:89], v[104:105] op_sel:[1,1,0] op_sel_hi:[0,1,1] neg_lo:[0,1,0]
  v_cvt_pk_bf16_f32 v189, v102, v103
  v_cvt_pk_bf16_f32 v191, v104, v105
  ds_write2_b32 v31, v191, v189 offset0:204 offset1:136
  v_pk_mul_f32 v[100:101], v[102:103], v[88:89] op_sel_hi:[1,0]
  v_pk_mul_f32 v[106:107], v[104:105], v[88:89] op_sel_hi:[1,0]
  v_pk_fma_f32 v[100:101], v[102:103], v[88:89], v[100:101] op_sel:[1,1,0] op_sel_hi:[0,1,1] neg_lo:[0,1,0]
  v_pk_fma_f32 v[106:107], v[104:105], v[88:89], v[106:107] op_sel:[1,1,0] op_sel_hi:[0,1,1] neg_lo:[0,1,0]
  v_cvt_pk_bf16_f32 v184, v100, v101
  v_cvt_pk_bf16_f32 v190, v106, v107
  ds_write2_b32 v118, v190, v184 offset0:68 offset1:0
  v_pk_mul_f32 v[102:103], v[100:101], v[88:89] op_sel_hi:[1,0]
  v_pk_mul_f32 v[104:105], v[106:107], v[88:89] op_sel_hi:[1,0]
  v_pk_fma_f32 v[102:103], v[100:101], v[88:89], v[102:103] op_sel:[1,1,0] op_sel_hi:[0,1,1] neg_lo:[0,1,0]
  v_pk_fma_f32 v[104:105], v[106:107], v[88:89], v[104:105] op_sel:[1,1,0] op_sel_hi:[0,1,1] neg_lo:[0,1,0]
  v_cvt_pk_bf16_f32 v185, v102, v103
  v_cvt_pk_bf16_f32 v188, v104, v105
  ds_write2_b32 v118, v188, v185 offset0:204 offset1:136
  v_pk_mul_f32 v[100:101], v[102:103], v[88:89] op_sel_hi:[1,0]
  v_pk_mul_f32 v[106:107], v[104:105], v[88:89] op_sel_hi:[1,0]
  v_pk_fma_f32 v[100:101], v[102:103], v[88:89], v[100:101] op_sel:[1,1,0] op_sel_hi:[0,1,1] neg_lo:[0,1,0]
  v_pk_fma_f32 v[106:107], v[104:105], v[88:89], v[106:107] op_sel:[1,1,0] op_sel_hi:[0,1,1] neg_lo:[0,1,0]
  v_cvt_pk_bf16_f32 v186, v100, v101
  v_cvt_pk_bf16_f32 v187, v106, v107
  ds_write2_b32 v119, v187, v186 offset0:68 offset1:0
  v_pk_mul_f32 v[102:103], v[100:101], v[88:89] op_sel_hi:[1,0]
  v_pk_mul_f32 v[104:105], v[106:107], v[88:89] op_sel_hi:[1,0]
  v_pk_fma_f32 v[102:103], v[100:101], v[88:89], v[102:103] op_sel:[1,1,0] op_sel_hi:[0,1,1] neg_lo:[0,1,0]
  v_pk_fma_f32 v[104:105], v[106:107], v[88:89], v[104:105] op_sel:[1,1,0] op_sel_hi:[0,1,1] neg_lo:[0,1,0]
  v_cvt_pk_bf16_f32 v191, v102, v103
  v_cvt_pk_bf16_f32 v189, v104, v105
  ds_write2_b32 v119, v189, v191 offset0:204 offset1:136
  v_pk_mul_f32 v[90:91], v[102:103], v[88:89] op_sel_hi:[1,0]
  v_pk_fma_f32 v[90:91], v[102:103], v[88:89], v[90:91] op_sel:[1,1,0] op_sel_hi:[0,1,1] neg_lo:[0,1,0]
  v_pk_mul_f32 v[94:95], v[92:93], v[90:91] op_sel_hi:[1,0]
  v_pk_fma_f32 v[94:95], v[92:93], v[90:91], v[94:95] op_sel:[1,1,0] op_sel_hi:[0,1,1] neg_lo:[0,1,0]
  v_cvt_pk_bf16_f32 v190, v94, -v95
  v_pk_mul_f32 v[96:97], v[94:95], v[90:91] op_sel_hi:[1,0]
  v_pk_mul_f32 v[98:99], v[94:95], v[82:83] op_sel_hi:[1,0]
  v_pk_fma_f32 v[96:97], v[94:95], v[90:91], v[96:97] op_sel:[1,1,0] op_sel_hi:[0,1,1] neg_lo:[0,1,0]
  v_pk_fma_f32 v[98:99], v[94:95], v[82:83], v[98:99] op_sel:[1,1,0] op_sel_hi:[0,1,1] neg_lo:[0,1,0]
  v_cvt_pk_bf16_f32 v184, v96, -v97
  v_cvt_pk_bf16_f32 v188, v98, -v99
  ds_write2_b32 v23, v188, v190 offset0:68 offset1:0
  v_pk_mul_f32 v[94:95], v[96:97], v[90:91] op_sel_hi:[1,0]
  v_pk_mul_f32 v[100:101], v[98:99], v[82:83] op_sel_hi:[1,0]
  v_pk_mul_f32 v[102:103], v[96:97], v[84:85] op_sel_hi:[1,0]
  v_pk_fma_f32 v[94:95], v[96:97], v[90:91], v[94:95] op_sel:[1,1,0] op_sel_hi:[0,1,1] neg_lo:[0,1,0]
  v_pk_fma_f32 v[100:101], v[98:99], v[82:83], v[100:101] op_sel:[1,1,0] op_sel_hi:[0,1,1] neg_lo:[0,1,0]
  v_pk_fma_f32 v[102:103], v[96:97], v[84:85], v[102:103] op_sel:[1,1,0] op_sel_hi:[0,1,1] neg_lo:[0,1,0]
  v_cvt_pk_bf16_f32 v185, v94, -v95
  v_cvt_pk_bf16_f32 v187, v100, -v101
  v_cvt_pk_bf16_f32 v186, v102, -v103
  ds_write2_b32 v20, v186, v184 offset0:68 offset1:0
  v_pk_mul_f32 v[96:97], v[94:95], v[90:91] op_sel_hi:[1,0]
  v_pk_mul_f32 v[98:99], v[100:101], v[82:83] op_sel_hi:[1,0]
  v_pk_mul_f32 v[106:107], v[94:95], v[84:85] op_sel_hi:[1,0]
  v_pk_fma_f32 v[96:97], v[94:95], v[90:91], v[96:97] op_sel:[1,1,0] op_sel_hi:[0,1,1] neg_lo:[0,1,0]
  v_pk_fma_f32 v[98:99], v[100:101], v[82:83], v[98:99] op_sel:[1,1,0] op_sel_hi:[0,1,1] neg_lo:[0,1,0]
  v_pk_fma_f32 v[106:107], v[94:95], v[84:85], v[106:107] op_sel:[1,1,0] op_sel_hi:[0,1,1] neg_lo:[0,1,0]
  v_cvt_pk_bf16_f32 v189, v96, -v97
  v_cvt_pk_bf16_f32 v191, v98, -v99
  ds_write2_b32 v23, v191, v187 offset0:204 offset1:136
  v_cvt_pk_bf16_f32 v188, v106, -v107
  ds_write2_b32 v22, v188, v185 offset0:68 offset1:0
  v_pk_mul_f32 v[94:95], v[96:97], v[90:91] op_sel_hi:[1,0]
  v_pk_mul_f32 v[100:101], v[98:99], v[82:83] op_sel_hi:[1,0]
  v_pk_mul_f32 v[104:105], v[102:103], v[84:85] op_sel_hi:[1,0]
  v_pk_mul_f32 v[80:81], v[96:97], v[86:87] op_sel_hi:[1,0]
  v_pk_fma_f32 v[94:95], v[96:97], v[90:91], v[94:95] op_sel:[1,1,0] op_sel_hi:[0,1,1] neg_lo:[0,1,0]
  v_pk_fma_f32 v[100:101], v[98:99], v[82:83], v[100:101] op_sel:[1,1,0] op_sel_hi:[0,1,1] neg_lo:[0,1,0]
  v_pk_fma_f32 v[104:105], v[102:103], v[84:85], v[104:105] op_sel:[1,1,0] op_sel_hi:[0,1,1] neg_lo:[0,1,0]
  v_pk_fma_f32 v[80:81], v[96:97], v[86:87], v[80:81] op_sel:[1,1,0] op_sel_hi:[0,1,1] neg_lo:[0,1,0]
  v_cvt_pk_bf16_f32 v190, v94, -v95
  v_cvt_pk_bf16_f32 v186, v100, -v101
  ds_write_b32 v12, v186 offset:5984
  v_cvt_pk_bf16_f32 v184, v104, -v105
  ds_write_b32 v12, v184 offset:1632
  v_cvt_pk_bf16_f32 v191, v80, -v81
  ds_write2_b32 v24, v191, v189 offset0:68 offset1:0
  v_pk_mul_f32 v[96:97], v[94:95], v[90:91] op_sel_hi:[1,0]
  v_pk_mul_f32 v[88:89], v[106:107], v[84:85] op_sel_hi:[1,0]
  v_pk_mul_f32 v[108:109], v[94:95], v[86:87] op_sel_hi:[1,0]
  v_pk_fma_f32 v[96:97], v[94:95], v[90:91], v[96:97] op_sel:[1,1,0] op_sel_hi:[0,1,1] neg_lo:[0,1,0]
  v_pk_fma_f32 v[88:89], v[106:107], v[84:85], v[88:89] op_sel:[1,1,0] op_sel_hi:[0,1,1] neg_lo:[0,1,0]
  v_pk_fma_f32 v[108:109], v[94:95], v[86:87], v[108:109] op_sel:[1,1,0] op_sel_hi:[0,1,1] neg_lo:[0,1,0]
  v_cvt_pk_bf16_f32 v187, v96, -v97
  v_cvt_pk_bf16_f32 v188, v88, -v89
  ds_write_b32 v12, v188 offset:3536
  v_cvt_pk_bf16_f32 v185, v108, -v109
  ds_write2_b32 v24, v185, v190 offset0:204 offset1:136
  v_pk_mul_f32 v[94:95], v[96:97], v[90:91] op_sel_hi:[1,0]
  v_pk_mul_f32 v[80:81], v[96:97], v[86:87] op_sel_hi:[1,0]
  v_pk_fma_f32 v[94:95], v[96:97], v[90:91], v[94:95] op_sel:[1,1,0] op_sel_hi:[0,1,1] neg_lo:[0,1,0]
  v_pk_fma_f32 v[80:81], v[96:97], v[86:87], v[80:81] op_sel:[1,1,0] op_sel_hi:[0,1,1] neg_lo:[0,1,0]
  v_cvt_pk_bf16_f32 v186, v94, -v95
  v_cvt_pk_bf16_f32 v184, v80, -v81
  ds_write2_b32 v25, v184, v187 offset0:68 offset1:0
  v_pk_mul_f32 v[108:109], v[94:95], v[86:87] op_sel_hi:[1,0]
  v_pk_fma_f32 v[108:109], v[94:95], v[86:87], v[108:109] op_sel:[1,1,0] op_sel_hi:[0,1,1] neg_lo:[0,1,0]
  v_cvt_pk_bf16_f32 v191, v108, -v109
  ds_write2_b32 v25, v191, v186 offset0:204 offset1:136
  s_setprio 0
  s_cmp_eq_u32 s44, 0
  s_cbranch_scc0 L_pt3293b
  s_branch L_pt3293e
L_pt3293b:
  s_mov_b32 s20, s52
  s_mov_b32 s21, s53
  s_mov_b32 s48, 2621440
  s_mov_b32 s27, 0
  s_sub_u32 s49, s35, 0
  s_and_b32 s31, s49, 1
  s_cmp_eq_u32 s31, 0
  s_cselect_b32 s24, s86, s88
  s_cselect_b32 s25, s87, s89
  s_lshr_b32 s26, s49, 1
  s_add_u32 s26, s26, 52
  s_mul_i32 s26, s26, 40960
  s_cmp_lt_u32 s49, 24
  s_cselect_b32 s20, s24, s20
  s_cselect_b32 s21, s25, s21
  s_cselect_b32 s48, s26, s48
  s_sub_u32 s49, s35, 24
  s_mov_b32 s24, s84
  s_mov_b32 s25, s85
  s_add_u32 s26, s49, 0
  s_mul_i32 s26, s26, 40960
  s_cmp_lt_u32 s49, 16
  s_cselect_b32 s20, s24, s20
  s_cselect_b32 s21, s25, s21
  s_cselect_b32 s48, s26, s48
  s_sub_u32 s49, s35, 40
  s_mov_b32 s24, s52
  s_mov_b32 s25, s53
  s_add_u32 s26, s49, 32
  s_mul_i32 s26, s26, 40960
  s_cmp_lt_u32 s49, 32
  s_cselect_b32 s20, s24, s20
  s_cselect_b32 s21, s25, s21
  s_cselect_b32 s48, s26, s48
  s_and_b32 s21, s21, 0xffff
  s_mov_b32 s22, 2621440
  s_mov_b32 s23, 0x20000
  buffer_load_dword v57, v62, s[20:23], s48 offen
L_pt3293e:
  s_waitcnt lgkmcnt(0)
  ds_read_b128 v[120:123], v13 offset:0
  ds_read_b128 v[152:155], v15 offset:0
  ds_read_b128 v[124:127], v13 offset:32
  ds_read_b128 v[156:159], v15 offset:32
  ds_read_b128 v[128:131], v13 offset:64
  ds_read_b128 v[160:163], v15 offset:64
  ds_read_b128 v[132:135], v13 offset:96
  ds_read_b128 v[164:167], v15 offset:96
  ds_read_b128 v[136:139], v13 offset:128
  ds_read_b128 v[168:171], v15 offset:128
  ds_read_b128 v[140:143], v13 offset:160
  ds_read_b128 v[172:175], v15 offset:160
  s_waitcnt lgkmcnt(8)
  ds_read_b128 v[144:147], v13 offset:192
  ds_read_b128 v[176:179], v15 offset:192
  ds_read_b128 v[148:151], v13 offset:224
  ds_read_b128 v[180:183], v15 offset:224
  s_waitcnt lgkmcnt(0)
  v_mfma_f32_32x32x16_bf16 v[64:79], v[120:123], v[152:155], 0
  v_mfma_f32_32x32x16_bf16 v[64:79], v[124:127], v[156:159], v[64:79]
  v_mfma_f32_32x32x16_bf16 v[64:79], v[128:131], v[160:163], v[64:79]
  v_mfma_f32_32x32x16_bf16 v[64:79], v[132:135], v[164:167], v[64:79]
  v_mfma_f32_32x32x16_bf16 v[64:79], v[136:139], v[168:171], v[64:79]
  v_mfma_f32_32x32x16_bf16 v[64:79], v[140:143], v[172:175], v[64:79]
  v_mfma_f32_32x32x16_bf16 v[64:79], v[144:147], v[176:179], v[64:79]
  v_mfma_f32_32x32x16_bf16 v[64:79], v[148:151], v[180:183], v[64:79]
  s_cmp_eq_u32 s44, 0
  s_cbranch_scc0 L_A_p2y
  s_setprio 1
  v_lshlrev_b32 v114, 16, v44
  v_lshlrev_b32 v115, 16, v45
  v_lshlrev_b32 v116, 16, v46
  v_lshlrev_b32 v117, 16, v47
  v_mul_f32 v32, 0x3fb8aa3b, v114
  v_mul_f32 v33, v115, v16
  v_exp_f32 v32, v32
  v_mul_f32 v33, 0.15915494, v33
  v_mul_f32 v92, v116, v17
  v_cvt_pk_bf16_f32 v32, v32, v32
  v_fract_f32 v33, v33
  v_and_b32 v32, v11, v32
  v_mul_f32 v93, v117, v17
  buffer_load_dwordx2 v[48:49], v63, s[8:11], s34 offen offset:0
  v_mul_f32 v32, v32, v16
  v_cos_f32 v34, v33
  v_mul_f32 v32, 0xbfb8aa3b, v32
  v_sin_f32 v35, v33
  v_exp_f32 v32, v32
  v_cvt_pk_bf16_f32 v184, v92, -v93
  v_mul_f32 v80, v32, v34
  v_mul_f32 v81, v32, v35
  v_pk_mul_f32 v[82:83], v[80:81], v[80:81] op_sel_hi:[1,0]
  v_pk_mul_f32 v[94:95], v[92:93], v[80:81] op_sel_hi:[1,0]
  v_pk_fma_f32 v[82:83], v[80:81], v[80:81], v[82:83] op_sel:[1,1,0] op_sel_hi:[0,1,1] neg_lo:[0,1,0]
  v_pk_fma_f32 v[94:95], v[92:93], v[80:81], v[94:95] op_sel:[1,1,0] op_sel_hi:[0,1,1] neg_lo:[0,1,0]
  v_cvt_pk_bf16_f32 v185, v94, -v95
  ds_write2_b32 v19, v185, v184 offset0:68 offset1:0
  v_pk_mul_f32 v[84:85], v[82:83], v[82:83] op_sel_hi:[1,0]
  v_pk_mul_f32 v[96:97], v[94:95], v[80:81] op_sel_hi:[1,0]
  v_pk_fma_f32 v[84:85], v[82:83], v[82:83], v[84:85] op_sel:[1,1,0] op_sel_hi:[0,1,1] neg_lo:[0,1,0]
  v_pk_fma_f32 v[96:97], v[94:95], v[80:81], v[96:97] op_sel:[1,1,0] op_sel_hi:[0,1,1] neg_lo:[0,1,0]
  v_cvt_pk_bf16_f32 v186, v96, -v97
  v_pk_mul_f32 v[86:87], v[84:85], v[84:85] op_sel_hi:[1,0]
  v_pk_mul_f32 v[98:99], v[96:97], v[80:81] op_sel_hi:[1,0]
  v_pk_fma_f32 v[86:87], v[84:85], v[84:85], v[86:87] op_sel:[1,1,0] op_sel_hi:[0,1,1] neg_lo:[0,1,0]
  v_pk_fma_f32 v[98:99], v[96:97], v[80:81], v[98:99] op_sel:[1,1,0] op_sel_hi:[0,1,1] neg_lo:[0,1,0]
  v_cvt_pk_bf16_f32 v187, v98, -v99
  ds_write2_b32 v19, v187, v186 offset0:204 offset1:136
  v_pk_mul_f32 v[88:89], v[86:87], v[86:87] op_sel_hi:[1,0]
  v_pk_mul_f32 v[94:95], v[98:99], v[80:81] op_sel_hi:[1,0]
  v_pk_fma_f32 v[88:89], v[86:87], v[86:87], v[88:89] op_sel:[1,1,0] op_sel_hi:[0,1,1] neg_lo:[0,1,0]
  v_pk_fma_f32 v[94:95], v[98:99], v[80:81], v[94:95] op_sel:[1,1,0] op_sel_hi:[0,1,1] neg_lo:[0,1,0]
  v_cvt_pk_bf16_f32 v188, v94, -v95
  v_pk_mul_f32 v[108:109], v[88:89], v[88:89] op_sel_hi:[1,0]
  v_pk_mul_f32 v[96:97], v[94:95], v[80:81] op_sel_hi:[1,0]
  buffer_load_dwordx2 v[50:51], v63, s[8:11], s34 offen offset:1280
  v_pk_fma_f32 v[108:109], v[88:89], v[88:89], v[108:109] op_sel:[1,1,0] op_sel_hi:[0,1,1] neg_lo:[0,1,0]
  v_pk_fma_f32 v[96:97], v[94:95], v[80:81], v[96:97] op_sel:[1,1,0] op_sel_hi:[0,1,1] neg_lo:[0,1,0]
  v_cvt_pk_bf16_f32 v189, v96, -v97
  ds_write2_b32 v21, v189, v188 offset0:68 offset1:0
  v_pk_mul_f32 v[110:111], v[108:109], v[108:109] op_sel_hi:[1,0]
  v_pk_mul_f32 v[98:99], v[96:97], v[80:81] op_sel_hi:[1,0]
  v_pk_fma_f32 v[110:111], v[108:109], v[108:109], v[110:111] op_sel:[1,1,0] op_sel_hi:[0,1,1] neg_lo:[0,1,0]
  v_pk_fma_f32 v[98:99], v[96:97], v[80:81], v[98:99] op_sel:[1,1,0] op_sel_hi:[0,1,1] neg_lo:[0,1,0]
  v_cvt_pk_bf16_f32 v190, v98, -v99
  v_pk_mul_f32 v[108:109], v[110:111], v[110:111] op_sel_hi:[1,0]
  v_pk_mul_f32 v[94:95], v[98:99], v[80:81] op_sel_hi:[1,0]
  v_pk_fma_f32 v[108:109], v[110:111], v[110:111], v[108:109] op_sel:[1,1,0] op_sel_hi:[0,1,1] neg_lo:[0,1,0]
  v_pk_fma_f32 v[94:95], v[98:99], v[80:81], v[94:95] op_sel:[1,1,0] op_sel_hi:[0,1,1] neg_lo:[0,1,0]
  v_cvt_pk_bf16_f32 v191, v94, -v95
  ds_write2_b32 v21, v191, v190 offset0:204 offset1:136
  v_pk_mul_f32 v[90:91], v[108:109], v[108:109] op_sel_hi:[1,0]
  v_pk_fma_f32 v[90:91], v[108:109], v[108:109], v[90:91] op_sel:[1,1,0] op_sel_hi:[0,1,1] neg_lo:[0,1,0]
  v_pk_mul_f32 v[94:95], v[92:93], v[90:91] op_sel_hi:[1,0]
  v_pk_fma_f32 v[94:95], v[92:93], v[90:91], v[94:95] op_sel:[1,1,0] op_sel_hi:[0,1,1] neg_lo:[0,1,0]
  v_cvt_pk_bf16_f32 v185, v94, -v95
  v_pk_mul_f32 v[96:97], v[94:95], v[90:91] op_sel_hi:[1,0]
  v_pk_mul_f32 v[98:99], v[94:95], v[82:83] op_sel_hi:[1,0]
  v_pk_fma_f32 v[96:97], v[94:95], v[90:91], v[96:97] op_sel:[1,1,0] op_sel_hi:[0,1,1] neg_lo:[0,1,0]
  v_pk_fma_f32 v[98:99], v[94:95], v[82:83], v[98:99] op_sel:[1,1,0] op_sel_hi:[0,1,1] neg_lo:[0,1,0]
  v_cvt_pk_bf16_f32 v184, v96, -v97
  v_cvt_pk_bf16_f32 v187, v98, -v99
  ds_write2_b32 v23, v187, v185 offset0:68 offset1:0
  v_pk_mul_f32 v[94:95], v[96:97], v[90:91] op_sel_hi:[1,0]
  v_pk_mul_f32 v[100:101], v[98:99], v[82:83] op_sel_hi:[1,0]
  v_pk_mul_f32 v[102:103], v[96:97], v[84:85] op_sel_hi:[1,0]
  v_pk_fma_f32 v[94:95], v[96:97], v[90:91], v[94:95] op_sel:[1,1,0] op_sel_hi:[0,1,1] neg_lo:[0,1,0]
  v_pk_fma_f32 v[100:101], v[98:99], v[82:83], v[100:101] op_sel:[1,1,0] op_sel_hi:[0,1,1] neg_lo:[0,1,0]
  v_pk_fma_f32 v[102:103], v[96:97], v[84:85], v[102:103] op_sel:[1,1,0] op_sel_hi:[0,1,1] neg_lo:[0,1,0]
  buffer_load_dwordx2 v[52:53], v63, s[8:11], s34 offen offset:2560
  v_cvt_pk_bf16_f32 v186, v94, -v95
  v_cvt_pk_bf16_f32 v189, v100, -v101
  v_cvt_pk_bf16_f32 v188, v102, -v103
  ds_write2_b32 v20, v188, v184 offset0:68 offset1:0
  v_pk_mul_f32 v[96:97], v[94:95], v[90:91] op_sel_hi:[1,0]
  v_pk_mul_f32 v[98:99], v[100:101], v[82:83] op_sel_hi:[1,0]
  v_pk_mul_f32 v[106:107], v[94:95], v[84:85] op_sel_hi:[1,0]
  v_pk_fma_f32 v[96:97], v[94:95], v[90:91], v[96:97] op_sel:[1,1,0] op_sel_hi:[0,1,1] neg_lo:[0,1,0]
  v_pk_fma_f32 v[98:99], v[100:101], v[82:83], v[98:99] op_sel:[1,1,0] op_sel_hi:[0,1,1] neg_lo:[0,1,0]
  v_pk_fma_f32 v[106:107], v[94:95], v[84:85], v[106:107] op_sel:[1,1,0] op_sel_hi:[0,1,1] neg_lo:[0,1,0]
  v_cvt_pk_bf16_f32 v191, v96, -v97
  v_cvt_pk_bf16_f32 v190, v98, -v99
  ds_write2_b32 v23, v190, v189 offset0:204 offset1:136
  v_cvt_pk_bf16_f32 v187, v106, -v107
  ds_write2_b32 v22, v187, v186 offset0:68 offset1:0
  v_pk_mul_f32 v[94:95], v[96:97], v[90:91] op_sel_hi:[1,0]
  v_pk_mul_f32 v[100:101], v[98:99], v[82:83] op_sel_hi:[1,0]
  v_pk_mul_f32 v[104:105], v[102:103], v[84:85] op_sel_hi:[1,0]
  v_pk_mul_f32 v[80:81], v[96:97], v[86:87] op_sel_hi:[1,0]
  v_pk_fma_f32 v[94:95], v[96:97], v[90:91], v[94:95] op_sel:[1,1,0] op_sel_hi:[0,1,1] neg_lo:[0,1,0]
  v_pk_fma_f32 v[100:101], v[98:99], v[82:83], v[100:101] op_sel:[1,1,0] op_sel_hi:[0,1,1] neg_lo:[0,1,0]
  v_pk_fma_f32 v[104:105], v[102:103], v[84:85], v[104:105] op_sel:[1,1,0] op_sel_hi:[0,1,1] neg_lo:[0,1,0]
  v_pk_fma_f32 v[80:81], v[96:97], v[86:87], v[80:81] op_sel:[1,1,0] op_sel_hi:[0,1,1] neg_lo:[0,1,0]
  v_cvt_pk_bf16_f32 v185, v94, -v95
  v_cvt_pk_bf16_f32 v188, v100, -v101
  ds_write_b32 v12, v188 offset:5984
  v_cvt_pk_bf16_f32 v184, v104, -v105
  ds_write_b32 v12, v184 offset:1632
  v_cvt_pk_bf16_f32 v190, v80, -v81
  ds_write2_b32 v24, v190, v191 offset0:68 offset1:0
  v_pk_mul_f32 v[96:97], v[94:95], v[90:91] op_sel_hi:[1,0]
  v_pk_mul_f32 v[88:89], v[106:107], v[84:85] op_sel_hi:[1,0]
  buffer_load_dwordx2 v[54:55], v63, s[8:11], s34 offen offset:3840
  v_pk_mul_f32 v[108:109], v[94:95], v[86:87] op_sel_hi:[1,0]
  v_pk_fma_f32 v[96:97], v[94:95], v[90:91], v[96:97] op_sel:[1,1,0] op_sel_hi:[0,1,1] neg_lo:[0,1,0]
  v_pk_fma_f32 v[88:89], v[106:107], v[84:85], v[88:89] op_sel:[1,1,0] op_sel_hi:[0,1,1] neg_lo:[0,1,0]
  v_pk_fma_f32 v[108:109], v[94:95], v[86:87], v[108:109] op_sel:[1,1,0] op_sel_hi:[0,1,1] neg_lo:[0,1,0]
  v_cvt_pk_bf16_f32 v189, v96, -v97
  v_cvt_pk_bf16_f32 v187, v88, -v89
  ds_write_b32 v12, v187 offset:3536
  v_cvt_pk_bf16_f32 v186, v108, -v109
  ds_write2_b32 v24, v186, v185 offset0:204 offset1:136
  v_pk_mul_f32 v[94:95], v[96:97], v[90:91] op_sel_hi:[1,0]
  v_pk_mul_f32 v[80:81], v[96:97], v[86:87] op_sel_hi:[1,0]
  v_pk_fma_f32 v[94:95], v[96:97], v[90:91], v[94:95] op_sel:[1,1,0] op_sel_hi:[0,1,1] neg_lo:[0,1,0]
  v_pk_fma_f32 v[80:81], v[96:97], v[86:87], v[80:81] op_sel:[1,1,0] op_sel_hi:[0,1,1] neg_lo:[0,1,0]
  v_cvt_pk_bf16_f32 v188, v94, -v95
  v_cvt_pk_bf16_f32 v184, v80, -v81
  ds_write2_b32 v25, v184, v189 offset0:68 offset1:0
  v_pk_mul_f32 v[108:109], v[94:95], v[86:87] op_sel_hi:[1,0]
  v_pk_fma_f32 v[108:109], v[94:95], v[86:87], v[108:109] op_sel:[1,1,0] op_sel_hi:[0,1,1] neg_lo:[0,1,0]
  v_cvt_pk_bf16_f32 v190, v108, -v109
  ds_write2_b32 v25, v190, v188 offset0:204 offset1:136
  s_setprio 0
  s_branch L_A_p2e
L_A_p2y:
  v_lshlrev_b32 v114, 16, v44
  v_lshlrev_b32 v115, 16, v45
  v_mul_f32 v32, 0x3fb8aa3b, v114
  v_mul_f32 v33, v115, v16
  v_exp_f32 v32, v32
  v_mul_f32 v33, 0.15915494, v33
  v_cvt_pk_bf16_f32 v32, v32, v32
  v_fract_f32 v33, v33
  v_and_b32 v32, v11, v32
  v_mul_f32 v32, v32, v16
  v_cos_f32 v34, v33
  v_mul_f32 v32, 0xbfb8aa3b, v32
  v_sin_f32 v35, v33
  v_exp_f32 v32, v32
  s_nop 0
  v_mul_f32 v80, v32, v34
  v_mul_f32 v81, v32, v35
  v_mov_b32 v184, 0x3f80
  v_pk_mul_f32 v[82:83], v[80:81], v[80:81] op_sel_hi:[1,0]
  v_pk_fma_f32 v[82:83], v[80:81], v[80:81], v[82:83] op_sel:[1,1,0] op_sel_hi:[0,1,1] neg_lo:[0,1,0]
  v_pk_mul_f32 v[84:85], v[82:83], v[82:83] op_sel_hi:[1,0]
  v_pk_fma_f32 v[84:85], v[82:83], v[82:83], v[84:85] op_sel:[1,1,0] op_sel_hi:[0,1,1] neg_lo:[0,1,0]
  v_pk_mul_f32 v[86:87], v[84:85], v[84:85] op_sel_hi:[1,0]
  v_pk_fma_f32 v[86:87], v[84:85], v[84:85], v[86:87] op_sel:[1,1,0] op_sel_hi:[0,1,1] neg_lo:[0,1,0]
  v_cvt_pk_bf16_f32 v185, v86, v87
  ds_write2_b32 v26, v185, v184 offset0:68 offset1:0
  v_pk_mul_f32 v[88:89], v[86:87], v[86:87] op_sel_hi:[1,0]
  v_pk_fma_f32 v[88:89], v[86:87], v[86:87], v[88:89] op_sel:[1,1,0] op_sel_hi:[0,1,1] neg_lo:[0,1,0]
  v_pk_mul_f32 v[104:105], v[86:87], v[88:89] op_sel_hi:[1,0]
  v_pk_fma_f32 v[104:105], v[86:87], v[88:89], v[104:105] op_sel:[1,1,0] op_sel_hi:[0,1,1] neg_lo:[0,1,0]
  v_cvt_pk_bf16_f32 v186, v88, v89
  v_cvt_pk_bf16_f32 v187, v104, v105
  ds_write2_b32 v26, v187, v186 offset0:204 offset1:136
  v_pk_mul_f32 v[100:101], v[88:89], v[88:89] op_sel_hi:[1,0]
  v_pk_mul_f32 v[106:107], v[104:105], v[88:89] op_sel_hi:[1,0]
  v_pk_fma_f32 v[100:101], v[88:89], v[88:89], v[100:101] op_sel:[1,1,0] op_sel_hi:[0,1,1] neg_lo:[0,1,0]
  v_pk_fma_f32 v[106:107], v[104:105], v[88:89], v[106:107] op_sel:[1,1,0] op_sel_hi:[0,1,1] neg_lo:[0,1,0]
  v_cvt_pk_bf16_f32 v188, v100, v101
  v_cvt_pk_bf16_f32 v189, v106, v107
  ds_write2_b32 v27, v189, v188 offset0:68 offset1:0
  v_pk_mul_f32 v[102:103], v[100:101], v[88:89] op_sel_hi:[1,0]
  v_pk_mul_f32 v[104:105], v[106:107], v[88:89] op_sel_hi:[1,0]
  v_pk_fma_f32 v[102:103], v[100:101], v[88:89], v[102:103] op_sel:[1,1,0] op_sel_hi:[0,1,1] neg_lo:[0,1,0]
  v_pk_fma_f32 v[104:105], v[106:107], v[88:89], v[104:105] op_sel:[1,1,0] op_sel_hi:[0,1,1] neg_lo:[0,1,0]
  v_cvt_pk_bf16_f32 v190, v102, v103
  v_cvt_pk_bf16_f32 v191, v104, v105
  ds_write2_b32 v27, v191, v190 offset0:204 offset1:136
  v_pk_mul_f32 v[100:101], v[102:103], v[88:89] op_sel_hi:[1,0]
  v_pk_mul_f32 v[106:107], v[104:105], v[88:89] op_sel_hi:[1,0]
  v_pk_fma_f32 v[100:101], v[102:103], v[88:89], v[100:101] op_sel:[1,1,0] op_sel_hi:[0,1,1] neg_lo:[0,1,0]
  v_pk_fma_f32 v[106:107], v[104:105], v[88:89], v[106:107] op_sel:[1,1,0] op_sel_hi:[0,1,1] neg_lo:[0,1,0]
  v_cvt_pk_bf16_f32 v185, v100, v101
  v_cvt_pk_bf16_f32 v184, v106, v107
  ds_write2_b32 v28, v184, v185 offset0:68 offset1:0
  v_pk_mul_f32 v[102:103], v[100:101], v[88:89] op_sel_hi:[1,0]
  v_pk_mul_f32 v[104:105], v[106:107], v[88:89] op_sel_hi:[1,0]
  v_pk_fma_f32 v[102:103], v[100:101], v[88:89], v[102:103] op_sel:[1,1,0] op_sel_hi:[0,1,1] neg_lo:[0,1,0]
  v_pk_fma_f32 v[104:105], v[106:107], v[88:89], v[104:105] op_sel:[1,1,0] op_sel_hi:[0,1,1] neg_lo:[0,1,0]
  v_cvt_pk_bf16_f32 v187, v102, v103
  v_cvt_pk_bf16_f32 v186, v104, v105
  ds_write2_b32 v28, v186, v187 offset0:204 offset1:136
  v_pk_mul_f32 v[100:101], v[102:103], v[88:89] op_sel_hi:[1,0]
  v_pk_mul_f32 v[106:107], v[104:105], v[88:89] op_sel_hi:[1,0]
  v_pk_fma_f32 v[100:101], v[102:103], v[88:89], v[100:101] op_sel:[1,1,0] op_sel_hi:[0,1,1] neg_lo:[0,1,0]
  v_pk_fma_f32 v[106:107], v[104:105], v[88:89], v[106:107] op_sel:[1,1,0] op_sel_hi:[0,1,1] neg_lo:[0,1,0]
  v_cvt_pk_bf16_f32 v189, v100, v101
  v_cvt_pk_bf16_f32 v188, v106, v107
  ds_write2_b32 v29, v188, v189 offset0:68 offset1:0
  v_pk_mul_f32 v[102:103], v[100:101], v[88:89] op_sel_hi:[1,0]
  v_pk_mul_f32 v[104:105], v[106:107], v[88:89] op_sel_hi:[1,0]
  v_pk_fma_f32 v[102:103], v[100:101], v[88:89], v[102:103] op_sel:[1,1,0] op_sel_hi:[0,1,1] neg_lo:[0,1,0]
  v_pk_fma_f32 v[104:105], v[106:107], v[88:89], v[104:105] op_sel:[1,1,0] op_sel_hi:[0,1,1] neg_lo:[0,1,0]
  v_cvt_pk_bf16_f32 v191, v102, v103
  v_cvt_pk_bf16_f32 v190, v104, v105
  ds_write2_b32 v29, v190, v191 offset0:204 offset1:136
  v_pk_mul_f32 v[100:101], v[102:103], v[88:89] op_sel_hi:[1,0]
  v_pk_mul_f32 v[106:107], v[104:105], v[88:89] op_sel_hi:[1,0]
  v_pk_fma_f32 v[100:101], v[102:103], v[88:89], v[100:101] op_sel:[1,1,0] op_sel_hi:[0,1,1] neg_lo:[0,1,0]
  v_pk_fma_f32 v[106:107], v[104:105], v[88:89], v[106:107] op_sel:[1,1,0] op_sel_hi:[0,1,1] neg_lo:[0,1,0]
  v_cvt_pk_bf16_f32 v184, v100, v101
  v_cvt_pk_bf16_f32 v185, v106, v107
  ds_write2_b32 v30, v185, v184 offset0:68 offset1:0
  v_pk_mul_f32 v[102:103], v[100:101], v[88:89] op_sel_hi:[1,0]
  v_pk_mul_f32 v[104:105], v[106:107], v[88:89] op_sel_hi:[1,0]
  v_pk_fma_f32 v[102:103], v[100:101], v[88:89], v[102:103] op_sel:[1,1,0] op_sel_hi:[0,1,1] neg_lo:[0,1,0]
  v_pk_fma_f32 v[104:105], v[106:107], v[88:89], v[104:105] op_sel:[1,1,0] op_sel_hi:[0,1,1] neg_lo:[0,1,0]
  v_cvt_pk_bf16_f32 v186, v102, v103
  v_cvt_pk_bf16_f32 v187, v104, v105
  ds_write2_b32 v30, v187, v186 offset0:204 offset1:136
  v_pk_mul_f32 v[100:101], v[102:103], v[88:89] op_sel_hi:[1,0]
  v_pk_mul_f32 v[106:107], v[104:105], v[88:89] op_sel_hi:[1,0]
  v_pk_fma_f32 v[100:101], v[102:103], v[88:89], v[100:101] op_sel:[1,1,0] op_sel_hi:[0,1,1] neg_lo:[0,1,0]
  v_pk_fma_f32 v[106:107], v[104:105], v[88:89], v[106:107] op_sel:[1,1,0] op_sel_hi:[0,1,1] neg_lo:[0,1,0]
  v_cvt_pk_bf16_f32 v188, v100, v101
  v_cvt_pk_bf16_f32 v189, v106, v107
  ds_write2_b32 v31, v189, v188 offset0:68 offset1:0
  v_pk_mul_f32 v[102:103], v[100:101], v[88:89] op_sel_hi:[1,0]
  v_pk_mul_f32 v[104:105], v[106:107], v[88:89] op_sel_hi:[1,0]
  v_pk_fma_f32 v[102:103], v[100:101], v[88:89], v[102:103] op_sel:[1,1,0] op_sel_hi:[0,1,1] neg_lo:[0,1,0]
  v_pk_fma_f32 v[104:105], v[106:107], v[88:89], v[104:105] op_sel:[1,1,0] op_sel_hi:[0,1,1] neg_lo:[0,1,0]
  v_cvt_pk_bf16_f32 v190, v102, v103
  v_cvt_pk_bf16_f32 v191, v104, v105
  ds_write2_b32 v31, v191, v190 offset0:204 offset1:136
  v_pk_mul_f32 v[100:101], v[102:103], v[88:89] op_sel_hi:[1,0]
  v_pk_mul_f32 v[106:107], v[104:105], v[88:89] op_sel_hi:[1,0]
  v_pk_fma_f32 v[100:101], v[102:103], v[88:89], v[100:101] op_sel:[1,1,0] op_sel_hi:[0,1,1] neg_lo:[0,1,0]
  v_pk_fma_f32 v[106:107], v[104:105], v[88:89], v[106:107] op_sel:[1,1,0] op_sel_hi:[0,1,1] neg_lo:[0,1,0]
  v_cvt_pk_bf16_f32 v185, v100, v101
  v_cvt_pk_bf16_f32 v184, v106, v107
  ds_write2_b32 v118, v184, v185 offset0:68 offset1:0
  v_pk_mul_f32 v[102:103], v[100:101], v[88:89] op_sel_hi:[1,0]
  v_pk_mul_f32 v[104:105], v[106:107], v[88:89] op_sel_hi:[1,0]
  v_pk_fma_f32 v[102:103], v[100:101], v[88:89], v[102:103] op_sel:[1,1,0] op_sel_hi:[0,1,1] neg_lo:[0,1,0]
  v_pk_fma_f32 v[104:105], v[106:107], v[88:89], v[104:105] op_sel:[1,1,0] op_sel_hi:[0,1,1] neg_lo:[0,1,0]
  v_cvt_pk_bf16_f32 v187, v102, v103
  v_cvt_pk_bf16_f32 v186, v104, v105
  ds_write2_b32 v118, v186, v187 offset0:204 offset1:136
  v_pk_mul_f32 v[100:101], v[102:103], v[88:89] op_sel_hi:[1,0]
  v_pk_mul_f32 v[106:107], v[104:105], v[88:89] op_sel_hi:[1,0]
  v_pk_fma_f32 v[100:101], v[102:103], v[88:89], v[100:101] op_sel:[1,1,0] op_sel_hi:[0,1,1] neg_lo:[0,1,0]
  v_pk_fma_f32 v[106:107], v[104:105], v[88:89], v[106:107] op_sel:[1,1,0] op_sel_hi:[0,1,1] neg_lo:[0,1,0]
  v_cvt_pk_bf16_f32 v189, v100, v101
  v_cvt_pk_bf16_f32 v188, v106, v107
  ds_write2_b32 v119, v188, v189 offset0:68 offset1:0
  v_pk_mul_f32 v[102:103], v[100:101], v[88:89] op_sel_hi:[1,0]
  v_pk_mul_f32 v[104:105], v[106:107], v[88:89] op_sel_hi:[1,0]
  v_pk_fma_f32 v[102:103], v[100:101], v[88:89], v[102:103] op_sel:[1,1,0] op_sel_hi:[0,1,1] neg_lo:[0,1,0]
  v_pk_fma_f32 v[104:105], v[106:107], v[88:89], v[104:105] op_sel:[1,1,0] op_sel_hi:[0,1,1] neg_lo:[0,1,0]
  v_cvt_pk_bf16_f32 v191, v102, v103
  v_cvt_pk_bf16_f32 v190, v104, v105
  ds_write2_b32 v119, v190, v191 offset0:204 offset1:136
  v_pk_mul_f32 v[90:91], v[102:103], v[88:89] op_sel_hi:[1,0]
  v_pk_fma_f32 v[90:91], v[102:103], v[88:89], v[90:91] op_sel:[1,1,0] op_sel_hi:[0,1,1] neg_lo:[0,1,0]
L_A_p2e:
  s_mul_i32 s48, s44, 64192
  s_lshl_b32 s49, s44, 7
  s_sub_u32 s48, s49, s48
  v_add_u32 v13, s48, v13
  s_add_u32 s48, s48, 64192
  v_add_u32 v15, s48, v15
  s_waitcnt lgkmcnt(0)
  s_barrier
  ds_read_b128 v[120:123], v13 offset:0
  ds_read_b128 v[152:155], v15 offset:0
  ds_read_b128 v[124:127], v13 offset:32
  ds_read_b128 v[156:159], v15 offset:32
  ds_read_b128 v[128:131], v13 offset:64
  ds_read_b128 v[160:163], v15 offset:64
  ds_read_b128 v[132:135], v13 offset:96
  ds_read_b128 v[164:167], v15 offset:96
  s_waitcnt lgkmcnt(6)
  v_mfma_f32_32x32x16_bf16 v[64:79], v[120:123], v[152:155], v[64:79]
  s_waitcnt lgkmcnt(4)
  v_mfma_f32_32x32x16_bf16 v[64:79], v[124:127], v[156:159], v[64:79]
  s_waitcnt lgkmcnt(2)
  v_mfma_f32_32x32x16_bf16 v[64:79], v[128:131], v[160:163], v[64:79]
  s_waitcnt lgkmcnt(0)
  v_mfma_f32_32x32x16_bf16 v[64:79], v[132:135], v[164:167], v[64:79]
  s_nop 13
  s_cmp_eq_u32 s44, 0
  s_cbranch_scc0 L_A_xb
  ds_write_b128 v7, v[72:75]
  ds_write_b128 v7, v[76:79] offset:1024
  s_branch L_A_xc
L_A_xb:
  ds_write_b128 v7, v[64:67]
  ds_write_b128 v7, v[68:71] offset:1024
L_A_xc:
  v_mov_b32 v102, 0
  s_waitcnt lgkmcnt(0)
  s_barrier
  ds_read_b128 v[92:95], v8
  ds_read_b128 v[96:99], v8 offset:1024
  s_mov_b64 exec, 0xfffffff
  ds_write_b32 v36, v102 offset:0
  ds_write_b32 v36, v102 offset:1216
  ds_write_b32 v36, v102 offset:2432
  ds_write_b32 v36, v102 offset:3648
  s_mov_b64 exec, -1
  s_cmp_eq_u32 s44, 0
  s_cbranch_scc0 L_A_fb
  s_waitcnt lgkmcnt(0)
  v_add_f32 v64, v64, v92
  v_add_f32 v65, v65, v93
  v_add_f32 v66, v66, v94
  v_add_f32 v67, v67, v95
  v_add_f32 v68, v68, v96
  v_add_f32 v69, v69, v97
  v_add_f32 v70, v70, v98
  v_add_f32 v71, v71, v99
  s_mov_b64 exec, 1
  v_add_f32 v64, s37, v64
  s_mov_b32 exec_lo, -1
  s_mov_b32 exec_hi, 0
  v_cvt_pk_bf16_f32 v102, v64, v68
  v_cvt_pk_bf16_f32 v103, v65, v69
  v_cvt_pk_bf16_f32 v104, v66, v70
  v_cvt_pk_bf16_f32 v105, v67, v71
  ds_write_b32 v18, v102 offset:112
  ds_write_b32 v18, v103 offset:1328
  ds_write_b32 v18, v104 offset:2544
  ds_write_b32 v18, v105 offset:3760
  s_mov_b32 exec_lo, 0
  s_mov_b32 exec_hi, -1
  v_cvt_pk_bf16_f32 v106, v64, v65
  v_cvt_pk_bf16_f32 v107, v64, v66
  v_cvt_pk_bf16_f32 v108, v65, v66
  ds_write_b32 v18, v106 offset:368
  ds_write_b32 v18, v106 offset:1584
  ds_write_b32 v18, v107 offset:2800
  ds_write_b32 v18, v108 offset:4016
  v_cvt_pk_bf16_f32 v109, v68, v69
  v_cvt_pk_bf16_f32 v110, v68, v70
  v_cvt_pk_bf16_f32 v111, v69, v70
  ds_write_b32 v18, v109 offset:496
  ds_write_b32 v18, v109 offset:1712
  ds_write_b32 v18, v110 offset:2928
  ds_write_b32 v18, v111 offset:4144
  s_mov_b64 exec, -1
  s_waitcnt vmcnt(0)
  v_perm_b32 v92, v50, v48, s32
  v_perm_b32 v93, v54, v52, s32
  v_perm_b32 v94, v50, v48, s33
  v_perm_b32 v95, v54, v52, s33
  v_perm_b32 v96, v51, v49, s32
  v_perm_b32 v97, v55, v53, s32
  v_perm_b32 v98, v51, v49, s33
  v_perm_b32 v99, v55, v53, s33
  ds_write_b64 v9, v[92:93] offset:0
  ds_write_b64 v9, v[94:95] offset:4176
  ds_write_b64 v9, v[96:97] offset:8352
  ds_write_b64 v9, v[98:99] offset:12528
  s_branch L_A_fd
L_A_fb:
  s_waitcnt lgkmcnt(0)
  v_add_f32 v72, v72, v92
  v_add_f32 v73, v73, v93
  v_add_f32 v74, v74, v94
  v_add_f32 v75, v75, v95
  v_add_f32 v76, v76, v96
  v_add_f32 v77, v77, v97
  v_add_f32 v78, v78, v98
  v_add_f32 v79, v79, v99
  s_mov_b32 exec_lo, -1
  s_mov_b32 exec_hi, 0
  v_cvt_pk_bf16_f32 v102, v72, v74
  v_cvt_pk_bf16_f32 v103, v73, v75
  v_cvt_pk_bf16_f32 v104, v74, v76
  ds_write_b32 v18, v102 offset:240
  ds_write_b32 v18, v102 offset:1456
  ds_write_b32 v18, v103 offset:2672
  ds_write_b32 v18, v104 offset:3888
  s_mov_b32 exec_lo, 0
  s_mov_b32 exec_hi, -1
  v_cvt_pk_bf16_f32 v105, v72, v73
  v_perm_b32 v106, v105, v105, v14
  ds_write_b32 v18, v106 offset:624
  ds_write_b32 v18, v105 offset:1840
  ds_write_b32 v18, v105 offset:3056
  ds_write_b32 v18, v105 offset:4272
  v_cvt_pk_bf16_f32 v107, v74, v75
  v_perm_b32 v108, v107, v107, v14
  ds_write_b32 v18, v108 offset:752
  ds_write_b32 v18, v107 offset:1968
  ds_write_b32 v18, v107 offset:3184
  ds_write_b32 v18, v107 offset:4400
  v_cvt_pk_bf16_f32 v109, v76, v77
  v_perm_b32 v110, v109, v109, v14
  ds_write_b32 v18, v110 offset:880
  ds_write_b32 v18, v109 offset:2096
  ds_write_b32 v18, v109 offset:3312
  ds_write_b32 v18, v109 offset:4528
  v_cvt_pk_bf16_f32 v105, v78, v79
  v_perm_b32 v106, v105, v105, v14
  ds_write_b32 v18, v106 offset:1008
  ds_write_b32 v18, v105 offset:2224
  ds_write_b32 v18, v105 offset:3440
  ds_write_b32 v18, v105 offset:4656
  s_mov_b64 exec, -1
L_A_fd:
  s_waitcnt lgkmcnt(0)
  s_barrier
  s_cmp_eq_u32 s44, 0
  s_cbranch_scc0 L_A_Y
  ds_read_b128 a[12:15], v3 offset:96
  ds_read_b128 a[44:47], v3 offset:352
  ds_read_b128 a[8:11], v3 offset:64
  ds_read_b128 a[40:43], v3 offset:320
  ds_read_b128 a[4:7], v3 offset:32
  ds_read_b128 a[36:39], v3 offset:288
  ds_read_b128 a[0:3], v3 offset:0
  ds_read_b128 a[32:35], v3 offset:256
  s_setprio 2
  ds_read_b64_tr_b16 v[32:33], v2 offset:32
  ds_read_b64_tr_b16 v[34:35], v2 offset:0
  ds_read_b64_tr_b16 v[36:37], v2 offset:160
  ds_read_b64_tr_b16 v[38:39], v2 offset:128
  ds_read_b64_tr_b16 v[40:41], v2 offset:288
  ds_read_b64_tr_b16 v[42:43], v2 offset:256
  s_waitcnt lgkmcnt(4)
  v_mfma_f32_32x32x16_bf16 v[64:79], a[12:15], v[32:35], 0
  ds_read_b128 a[28:31], v3 offset:224
  ds_read_b128 a[24:27], v3 offset:192
  v_mfma_f32_32x32x16_bf16 v[96:111], a[44:47], v[32:35], 0
  ds_read_b128 a[20:23], v3 offset:160
  ds_read_b128 a[16:19], v3 offset:128
  ds_read_b64_tr_b16 v[44:45], v2 offset:416
  ds_read_b64_tr_b16 v[46:47], v2 offset:384
  s_waitcnt lgkmcnt(8)
  v_mfma_f32_32x32x16_bf16 v[64:79], a[8:11], v[36:39], v[64:79]
  ds_read_b128 v[92:95], v3 offset:608
  ds_read_b128 v[156:159], v3 offset:864
  v_mfma_f32_32x32x16_bf16 v[96:111], a[40:43], v[36:39], v[96:111]
  ds_read_b128 v[88:91], v3 offset:576
  ds_read_b128 v[152:155], v3 offset:832
  ds_read_b64_tr_b16 v[14:15], v2 offset:544
  ds_read_b64_tr_b16 v[16:17], v2 offset:512
  s_waitcnt lgkmcnt(12)
  v_mfma_f32_32x32x16_bf16 v[64:79], a[4:7], v[40:43], v[64:79]
  ds_read_b128 v[84:87], v3 offset:544
  ds_read_b128 v[148:151], v3 offset:800
  v_mfma_f32_32x32x16_bf16 v[96:111], a[36:39], v[40:43], v[96:111]
  ds_read_b128 v[80:83], v3 offset:512
  s_waitcnt lgkmcnt(14)
  ds_read_b128 v[144:147], v3 offset:768
  s_waitcnt lgkmcnt(14)
  ds_read_b64_tr_b16 v[18:19], v2 offset:672
  s_waitcnt lgkmcnt(14)
  ds_read_b64_tr_b16 v[20:21], v2 offset:640
  s_waitcnt lgkmcnt(14)
  ds_read_b64_tr_b16 v[22:23], v2 offset:800
  s_waitcnt lgkmcnt(14)
  ds_read_b64_tr_b16 v[24:25], v2 offset:768
  s_waitcnt lgkmcnt(14)
  v_mfma_f32_32x32x16_bf16 v[64:79], a[0:3], v[44:47], v[64:79]
  s_nop 11
  v_add_f32_dpp v28, v67, v66 wave_shr:1 row_mask:0xf bank_mask:0xf bound_ctrl:0
  s_nop 10
  v_add_f32_dpp v29, v67, v70 wave_ror:1 row_mask:0x1 bank_mask:0x1
  s_nop 9
  v_add_f32_dpp v29, v71, v70 wave_shr:1 row_mask:0xf bank_mask:0xf
  s_nop 8
  v_add_f32_dpp v30, v71, v74 wave_ror:1 row_mask:0x1 bank_mask:0x1
  s_nop 7
  v_add_f32_dpp v30, v75, v74 wave_shr:1 row_mask:0xf bank_mask:0xf
  s_nop 6
  v_add_f32_dpp v26, v75, v78 wave_ror:1 row_mask:0x1 bank_mask:0x1
  s_nop 5
  v_add_f32_dpp v26, v79, v78 wave_shr:1 row_mask:0xf bank_mask:0xf
  s_nop 4
  v_add_f32_dpp v66, v28, v65 wave_shr:1 row_mask:0xf bank_mask:0xf bound_ctrl:0
  s_nop 3
  v_add_f32_dpp v70, v28, v69 wave_ror:1 row_mask:0x1 bank_mask:0x1
  s_nop 2
  v_add_f32_dpp v70, v29, v69 wave_shr:1 row_mask:0xf bank_mask:0xf
  s_nop 1
  v_add_f32_dpp v74, v29, v73 wave_ror:1 row_mask:0x1 bank_mask:0x1
  s_nop 0
  v_add_f32_dpp v74, v30, v73 wave_shr:1 row_mask:0xf bank_mask:0xf
  ds_read_b128 a[60:63], v3 offset:480
  s_waitcnt lgkmcnt(14)
  ds_read_b128 a[56:59], v3 offset:448
  v_mfma_f32_32x32x16_bf16 v[96:111], a[32:35], v[44:47], v[96:111]
  v_add_f32_dpp v78, v30, v77 wave_ror:1 row_mask:0x1 bank_mask:0x1
  v_add_f32_dpp v78, v26, v77 wave_shr:1 row_mask:0xf bank_mask:0xf
  s_waitcnt lgkmcnt(14)
  ds_read_b128 a[52:55], v3 offset:416
  s_waitcnt lgkmcnt(14)
  ds_read_b128 a[48:51], v3 offset:384
  s_waitcnt lgkmcnt(14)
  ds_read_b64_tr_b16 v[160:161], v2 offset:928
  s_waitcnt lgkmcnt(14)
  ds_read_b64_tr_b16 v[162:163], v2 offset:896
  s_waitcnt lgkmcnt(14)
  ds_read_b64_tr_b16 v[164:165], v2 offset:1056
  s_waitcnt lgkmcnt(14)
  ds_read_b64_tr_b16 v[166:167], v2 offset:1024
  v_mfma_f32_32x32x16_bf16 v[96:111], a[28:31], v[14:17], v[96:111]
  v_add_f32_dpp v65, v66, v64 wave_shr:1 row_mask:0xf bank_mask:0xf bound_ctrl:0
  s_waitcnt lgkmcnt(14)
  ds_read_b128 v[124:127], v3 offset:736
  s_waitcnt lgkmcnt(14)
  ds_read_b128 v[120:123], v3 offset:704
  s_waitcnt lgkmcnt(14)
  ds_read_b64_tr_b16 v[168:169], v2 offset:1184
  s_waitcnt lgkmcnt(14)
  ds_read_b64_tr_b16 v[170:171], v2 offset:1152
  s_waitcnt lgkmcnt(14)
  v_mfma_f32_32x32x16_bf16 v[96:111], a[24:27], v[18:21], v[96:111]
  v_add_f32_dpp v69, v66, v68 wave_ror:1 row_mask:0x1 bank_mask:0x1
  v_add_f32_dpp v69, v70, v68 wave_shr:1 row_mask:0xf bank_mask:0xf
  ds_read_b128 v[116:119], v3 offset:672
  s_waitcnt lgkmcnt(14)
  ds_read_b128 v[112:115], v3 offset:640
  s_waitcnt lgkmcnt(14)
  ds_read_b64_tr_b16 v[172:173], v2 offset:1312
  s_waitcnt lgkmcnt(14)
  ds_read_b64_tr_b16 v[174:175], v2 offset:1280
  v_mfma_f32_32x32x16_bf16 v[96:111], a[20:23], v[22:25], v[96:111]
  v_add_f32_dpp v73, v70, v72 wave_ror:1 row_mask:0x1 bank_mask:0x1
  v_add_f32_dpp v73, v74, v72 wave_shr:1 row_mask:0xf bank_mask:0xf
  s_waitcnt lgkmcnt(14)
  ds_read_b64_tr_b16 v[32:33], v2 offset:1440
  s_waitcnt lgkmcnt(14)
  ds_read_b64_tr_b16 v[34:35], v2 offset:1408
  s_waitcnt lgkmcnt(12)
  v_mfma_f32_32x32x16_bf16 v[96:111], a[16:19], v[160:163], v[96:111]
  v_add_f32_dpp v77, v74, v76 wave_ror:1 row_mask:0x1 bank_mask:0x1
  v_add_f32_dpp v77, v78, v76 wave_shr:1 row_mask:0xf bank_mask:0xf
  ds_read_b64_tr_b16 v[36:37], v2 offset:32
  ds_read_b64_tr_b16 v[38:39], v2 offset:0
  s_waitcnt lgkmcnt(12)
  v_mfma_f32_32x32x16_bf16 v[96:111], a[12:15], v[164:167], v[96:111]
  s_waitcnt lgkmcnt(8)
  v_mfma_f32_32x32x16_bf16 v[96:111], a[8:11], v[168:171], v[96:111]
  s_mov_b32 m0, s47
  s_nop 0
  ds_write_addtid_b32 v65 offset:0
  ds_write_addtid_b32 v69 offset:256
  ds_write_addtid_b32 v73 offset:512
  ds_write_addtid_b32 v77 offset:768
  ds_read_b64_tr_b16 v[40:41], v2 offset:160
  ds_read_b64_tr_b16 v[42:43], v2 offset:128
  s_waitcnt lgkmcnt(10)
  v_mfma_f32_32x32x16_bf16 v[96:111], a[4:7], v[172:175], v[96:111]
  s_waitcnt lgkmcnt(8)
  v_mfma_f32_32x32x16_bf16 v[96:111], a[0:3], v[32:35], v[96:111]
  s_mov_b64 exec, s[40:41]
  ds_write_addtid_b32 v78 offset:772
  ds_write_addtid_b32 v26 offset:776
  ds_write_addtid_b32 v79 offset:780
  s_mov_b64 exec, -1
  s_waitcnt lgkmcnt(0)
  s_barrier
  s_setprio 0
  ds_read_b64_tr_b16 v[44:45], v2 offset:288
  ds_read_b64_tr_b16 v[46:47], v2 offset:256
  v_mfma_f32_32x32x16_bf16 v[128:143], v[92:95], v[36:39], 0
  s_nop 0
  v_add_f32_dpp v28, v99, v98 wave_shr:1 row_mask:0xf bank_mask:0xf bound_ctrl:0
  v_mfma_f32_32x32x16_bf16 v[160:175], v[156:159], v[36:39], 0
  v_add_f32_dpp v29, v99, v102 wave_ror:1 row_mask:0x1 bank_mask:0x1
  v_add_f32_dpp v29, v103, v102 wave_shr:1 row_mask:0xf bank_mask:0xf
  ds_read_b64_tr_b16 v[14:15], v2 offset:416
  ds_read_b64_tr_b16 v[16:17], v2 offset:384
  v_mfma_f32_32x32x16_bf16 v[128:143], v[88:91], v[40:43], v[128:143]
  v_add_f32_dpp v30, v103, v106 wave_ror:1 row_mask:0x1 bank_mask:0x1
  v_add_f32_dpp v30, v107, v106 wave_shr:1 row_mask:0xf bank_mask:0xf
  v_mfma_f32_32x32x16_bf16 v[160:175], v[152:155], v[40:43], v[160:175]
  v_add_f32_dpp v26, v107, v110 wave_ror:1 row_mask:0x1 bank_mask:0x1
  v_add_f32_dpp v26, v111, v110 wave_shr:1 row_mask:0xf bank_mask:0xf
  ds_read_b64_tr_b16 v[18:19], v2 offset:544
  ds_read_b64_tr_b16 v[20:21], v2 offset:512
  s_waitcnt lgkmcnt(4)
  v_mfma_f32_32x32x16_bf16 v[128:143], v[84:87], v[44:47], v[128:143]
  v_add_f32_dpp v98, v28, v97 wave_shr:1 row_mask:0xf bank_mask:0xf bound_ctrl:0
  v_add_f32_dpp v102, v28, v101 wave_ror:1 row_mask:0x1 bank_mask:0x1
  v_add_f32_dpp v102, v29, v101 wave_shr:1 row_mask:0xf bank_mask:0xf
  v_mfma_f32_32x32x16_bf16 v[160:175], v[148:151], v[44:47], v[160:175]
  ds_read_b64_tr_b16 v[22:23], v2 offset:672
  ds_read_b64_tr_b16 v[24:25], v2 offset:640
  ds_read_b64_tr_b16 v[32:33], v2 offset:800
  ds_read_b64_tr_b16 v[34:35], v2 offset:768
  s_waitcnt lgkmcnt(6)
  v_mfma_f32_32x32x16_bf16 v[128:143], v[80:83], v[14:17], v[128:143]
  v_add_f32_dpp v106, v29, v105 wave_ror:1 row_mask:0x1 bank_mask:0x1
  v_add_f32_dpp v106, v30, v105 wave_shr:1 row_mask:0xf bank_mask:0xf
  v_mfma_f32_32x32x16_bf16 v[160:175], v[144:147], v[14:17], v[160:175]
  v_add_f32_dpp v110, v30, v109 wave_ror:1 row_mask:0x1 bank_mask:0x1
  v_add_f32_dpp v110, v26, v109 wave_shr:1 row_mask:0xf bank_mask:0xf
  ds_read_b64_tr_b16 v[64:65], v2 offset:928
  ds_read_b64_tr_b16 v[66:67], v2 offset:896
  ds_read_b64_tr_b16 v[68:69], v2 offset:1056
  ds_read_b64_tr_b16 v[70:71], v2 offset:1024
  s_waitcnt lgkmcnt(8)
  v_mfma_f32_32x32x16_bf16 v[128:143], a[60:63], v[18:21], v[128:143]
  v_add_f32_dpp v97, v98, v96 wave_shr:1 row_mask:0xf bank_mask:0xf bound_ctrl:0
  v_add_f32_dpp v101, v98, v100 wave_ror:1 row_mask:0x1 bank_mask:0x1
  v_add_f32_dpp v101, v102, v100 wave_shr:1 row_mask:0xf bank_mask:0xf
  ds_read_b64_tr_b16 v[72:73], v2 offset:1184
  ds_read_b64_tr_b16 v[74:75], v2 offset:1152
  s_waitcnt lgkmcnt(8)
  v_mfma_f32_32x32x16_bf16 v[128:143], a[56:59], v[22:25], v[128:143]
  v_add_f32_dpp v105, v102, v104 wave_ror:1 row_mask:0x1 bank_mask:0x1
  v_add_f32_dpp v105, v106, v104 wave_shr:1 row_mask:0xf bank_mask:0xf
  ds_read_b64_tr_b16 v[76:77], v2 offset:1312
  ds_read_b64_tr_b16 v[78:79], v2 offset:1280
  s_waitcnt lgkmcnt(8)
  v_mfma_f32_32x32x16_bf16 v[128:143], a[52:55], v[32:35], v[128:143]
  ds_read_b64_tr_b16 v[36:37], v2 offset:1440
  ds_read_b64_tr_b16 v[38:39], v2 offset:1408
  s_waitcnt lgkmcnt(8)
  v_mfma_f32_32x32x16_bf16 v[128:143], a[48:51], v[64:67], v[128:143]
  v_add_f32_dpp v109, v106, v108 wave_ror:1 row_mask:0x1 bank_mask:0x1
  v_add_f32_dpp v109, v110, v108 wave_shr:1 row_mask:0xf bank_mask:0xf
  ds_read_b64_tr_b16 v[40:41], v2 offset:1568
  ds_read_b64_tr_b16 v[42:43], v2 offset:1536
  s_waitcnt lgkmcnt(8)
  v_mfma_f32_32x32x16_bf16 v[128:143], a[44:47], v[68:71], v[128:143]
  s_mov_b32 m0, s47
  s_nop 0
  ds_write_addtid_b32 v97 offset:8320
  ds_write_addtid_b32 v101 offset:8576
  ds_write_addtid_b32 v105 offset:8832
  ds_write_addtid_b32 v109 offset:9088
  ds_read_b64_tr_b16 v[44:45], v2 offset:1696
  ds_read_b64_tr_b16 v[46:47], v2 offset:1664
  s_waitcnt lgkmcnt(12)
  v_mfma_f32_32x32x16_bf16 v[128:143], a[40:43], v[72:75], v[128:143]
  ds_read_b64_tr_b16 v[14:15], v2 offset:1824
  ds_read_b64_tr_b16 v[16:17], v2 offset:1792
  s_waitcnt lgkmcnt(12)
  v_mfma_f32_32x32x16_bf16 v[128:143], a[36:39], v[76:79], v[128:143]
  s_mov_b64 exec, s[40:41]
  ds_write_addtid_b32 v110 offset:9092
  ds_write_addtid_b32 v26 offset:9096
  ds_write_addtid_b32 v111 offset:9100
  s_mov_b64 exec, -1
  s_waitcnt lgkmcnt(14)
  ds_read_b64_tr_b16 v[18:19], v2 offset:1952
  s_waitcnt lgkmcnt(14)
  ds_read_b64_tr_b16 v[20:21], v2 offset:1920
  v_mfma_f32_32x32x16_bf16 v[128:143], a[32:35], v[36:39], v[128:143]
  s_waitcnt lgkmcnt(14)
  ds_read_b32 v48, v5 offset:0
  s_waitcnt lgkmcnt(14)
  v_mfma_f32_32x32x16_bf16 v[128:143], a[28:31], v[40:43], v[128:143]
  ds_read_b32 v49, v5 offset:1040
  s_waitcnt lgkmcnt(14)
  ds_read_b32 v50, v5 offset:2080
  s_waitcnt lgkmcnt(10)
  v_mfma_f32_32x32x16_bf16 v[128:143], a[24:27], v[44:47], v[128:143]
  ds_read_b32 v51, v5 offset:3120
  s_waitcnt lgkmcnt(9)
  v_mfma_f32_32x32x16_bf16 v[128:143], a[20:23], v[14:17], v[128:143]
  s_waitcnt lgkmcnt(2)
  v_cvt_pk_bf16_f32 v56, v48, v49
  s_waitcnt lgkmcnt(0)
  v_cvt_pk_bf16_f32 v57, v50, v51
  v_mfma_f32_32x32x16_bf16 v[128:143], a[16:19], v[18:21], v[128:143]
  s_mov_b32 s46, 0
  buffer_store_dwordx2 v[56:57], v10, s[12:15], s46 offen
  s_barrier
  s_setprio 0
  ds_read_b64_tr_b16 v[22:23], v2 offset:2080
  ds_read_b64_tr_b16 v[24:25], v2 offset:2048
  ds_read_b64_tr_b16 v[32:33], v2 offset:2208
  ds_read_b64_tr_b16 v[34:35], v2 offset:2176
  ds_read_b64_tr_b16 v[64:65], v2 offset:2336
  ds_read_b64_tr_b16 v[66:67], v2 offset:2304
  ds_read_b64_tr_b16 v[68:69], v2 offset:2464
  ds_read_b64_tr_b16 v[70:71], v2 offset:2432
  ds_read_b64_tr_b16 v[72:73], v2 offset:544
  ds_read_b64_tr_b16 v[74:75], v2 offset:512
  s_waitcnt lgkmcnt(8)
  v_mfma_f32_32x32x16_bf16 v[128:143], a[12:15], v[22:25], v[128:143]
  ds_read_b32 v48, v5 offset:4160
  ds_read_b32 v49, v5 offset:5200
  ds_read_b32 v50, v5 offset:6240
  ds_read_b64_tr_b16 v[76:77], v2 offset:672
  ds_read_b64_tr_b16 v[78:79], v2 offset:640
  s_waitcnt lgkmcnt(11)
  v_mfma_f32_32x32x16_bf16 v[128:143], a[8:11], v[32:35], v[128:143]
  ds_read_b32 v51, v5 offset:7280
  v_mov_b32 v52, 0
  v_mov_b32 v53, 0
  v_mov_b32 v54, 0
  ds_read_b64_tr_b16 v[36:37], v2 offset:800
  ds_read_b64_tr_b16 v[38:39], v2 offset:768
  s_waitcnt lgkmcnt(12)
  v_mfma_f32_32x32x16_bf16 v[128:143], a[4:7], v[64:67], v[128:143]
  v_mov_b32 v55, 0
  s_mov_b64 exec, s[42:43]
  ds_read_b32 v52, v6 offset:0
  ds_read_b32 v53, v6 offset:1040
  ds_read_b32 v54, v6 offset:2080
  s_waitcnt lgkmcnt(14)
  ds_read_b32 v55, v6 offset:3120
  s_mov_b64 exec, -1
  s_waitcnt lgkmcnt(14)
  ds_read_b64_tr_b16 v[40:41], v2 offset:928
  s_waitcnt lgkmcnt(14)
  ds_read_b64_tr_b16 v[42:43], v2 offset:896
  v_mfma_f32_32x32x16_bf16 v[128:143], a[0:3], v[68:71], v[128:143]
  s_waitcnt lgkmcnt(5)
  v_fmac_f32 v48, s38, v52
  s_waitcnt lgkmcnt(4)
  v_fmac_f32 v49, s38, v53
  ds_read_b64_tr_b16 v[44:45], v2 offset:1056
  ds_read_b64_tr_b16 v[46:47], v2 offset:1024
  v_mfma_f32_32x32x16_bf16 v[160:175], v[124:127], v[72:75], v[160:175]
  s_waitcnt lgkmcnt(5)
  v_fmac_f32 v50, s38, v54
  s_waitcnt lgkmcnt(4)
  v_fmac_f32 v51, s38, v55
  v_cvt_pk_bf16_f32 v56, v48, v49
  ds_read_b64_tr_b16 v[14:15], v2 offset:1184
  ds_read_b64_tr_b16 v[16:17], v2 offset:1152
  v_mfma_f32_32x32x16_bf16 v[160:175], v[120:123], v[76:79], v[160:175]
  v_cvt_pk_bf16_f32 v57, v50, v51
  s_mov_b32 s46, 655360
  buffer_store_dwordx2 v[56:57], v10, s[12:15], s46 offen
  ds_read_b64_tr_b16 v[18:19], v2 offset:1312
  ds_read_b64_tr_b16 v[20:21], v2 offset:1280
  v_mfma_f32_32x32x16_bf16 v[160:175], v[116:119], v[36:39], v[160:175]
  v_add_f32_dpp v28, v131, v130 wave_shr:1 row_mask:0xf bank_mask:0xf bound_ctrl:0
  v_add_f32_dpp v29, v131, v134 wave_ror:1 row_mask:0x1 bank_mask:0x1
  v_add_f32_dpp v29, v135, v134 wave_shr:1 row_mask:0xf bank_mask:0xf
  ds_read_b64_tr_b16 v[96:97], v2 offset:1440
  ds_read_b64_tr_b16 v[98:99], v2 offset:1408
  s_waitcnt lgkmcnt(8)
  v_mfma_f32_32x32x16_bf16 v[160:175], v[112:115], v[40:43], v[160:175]
  v_add_f32_dpp v30, v135, v138 wave_ror:1 row_mask:0x1 bank_mask:0x1
  v_add_f32_dpp v30, v139, v138 wave_shr:1 row_mask:0xf bank_mask:0xf
  v_add_f32_dpp v26, v139, v142 wave_ror:1 row_mask:0x1 bank_mask:0x1
  v_add_f32_dpp v26, v143, v142 wave_shr:1 row_mask:0xf bank_mask:0xf
  ds_read_b64_tr_b16 v[100:101], v2 offset:1568
  ds_read_b64_tr_b16 v[102:103], v2 offset:1536
  s_waitcnt lgkmcnt(8)
  v_mfma_f32_32x32x16_bf16 v[160:175], v[92:95], v[44:47], v[160:175]
  v_add_f32_dpp v130, v28, v129 wave_shr:1 row_mask:0xf bank_mask:0xf bound_ctrl:0
  v_add_f32_dpp v134, v28, v133 wave_ror:1 row_mask:0x1 bank_mask:0x1
  v_add_f32_dpp v134, v29, v133 wave_shr:1 row_mask:0xf bank_mask:0xf
  ds_read_b64_tr_b16 v[104:105], v2 offset:1696
  ds_read_b64_tr_b16 v[106:107], v2 offset:1664
  s_waitcnt lgkmcnt(8)
  v_mfma_f32_32x32x16_bf16 v[160:175], v[88:91], v[14:17], v[160:175]
  v_add_f32_dpp v138, v29, v137 wave_ror:1 row_mask:0x1 bank_mask:0x1
  v_add_f32_dpp v138, v30, v137 wave_shr:1 row_mask:0xf bank_mask:0xf
  v_add_f32_dpp v142, v30, v141 wave_ror:1 row_mask:0x1 bank_mask:0x1
  v_add_f32_dpp v142, v26, v141 wave_shr:1 row_mask:0xf bank_mask:0xf
  ds_read_b64_tr_b16 v[108:109], v2 offset:1824
  ds_read_b64_tr_b16 v[110:111], v2 offset:1792
  s_waitcnt lgkmcnt(8)
  v_mfma_f32_32x32x16_bf16 v[160:175], v[84:87], v[18:21], v[160:175]
  v_add_f32_dpp v129, v130, v128 wave_shr:1 row_mask:0xf bank_mask:0xf bound_ctrl:0
  v_add_f32_dpp v133, v130, v132 wave_ror:1 row_mask:0x1 bank_mask:0x1
  v_add_f32_dpp v133, v134, v132 wave_shr:1 row_mask:0xf bank_mask:0xf
  ds_read_b64_tr_b16 v[22:23], v2 offset:1952
  ds_read_b64_tr_b16 v[24:25], v2 offset:1920
  s_waitcnt lgkmcnt(8)
  v_mfma_f32_32x32x16_bf16 v[160:175], v[80:83], v[96:99], v[160:175]
  v_add_f32_dpp v137, v134, v136 wave_ror:1 row_mask:0x1 bank_mask:0x1
  v_add_f32_dpp v137, v138, v136 wave_shr:1 row_mask:0xf bank_mask:0xf
  v_add_f32_dpp v141, v138, v140 wave_ror:1 row_mask:0x1 bank_mask:0x1
  v_add_f32_dpp v141, v142, v140 wave_shr:1 row_mask:0xf bank_mask:0xf
  ds_read_b64_tr_b16 v[32:33], v2 offset:2080
  ds_read_b64_tr_b16 v[34:35], v2 offset:2048
  s_waitcnt lgkmcnt(8)
  v_mfma_f32_32x32x16_bf16 v[160:175], a[60:63], v[100:103], v[160:175]
  s_mov_b32 m0, s47
  s_nop 0
  ds_write_addtid_b32 v129 offset:16640
  ds_write_addtid_b32 v133 offset:16896
  ds_write_addtid_b32 v137 offset:17152
  ds_write_addtid_b32 v141 offset:17408
  ds_read_b64_tr_b16 v[64:65], v2 offset:2208
  ds_read_b64_tr_b16 v[66:67], v2 offset:2176
  s_waitcnt lgkmcnt(12)
  v_mfma_f32_32x32x16_bf16 v[160:175], a[56:59], v[104:107], v[160:175]
  s_mov_b64 exec, s[40:41]
  ds_write_addtid_b32 v142 offset:17412
  ds_write_addtid_b32 v26 offset:17416
  ds_write_addtid_b32 v143 offset:17420
  s_mov_b64 exec, -1
  s_waitcnt lgkmcnt(14)
  ds_read_b64_tr_b16 v[68:69], v2 offset:2336
  s_waitcnt lgkmcnt(14)
  ds_read_b64_tr_b16 v[70:71], v2 offset:2304
  v_mfma_f32_32x32x16_bf16 v[160:175], a[52:55], v[108:111], v[160:175]
  s_waitcnt lgkmcnt(14)
  ds_read_b32 v48, v5 offset:8320
  s_waitcnt lgkmcnt(14)
  ds_read_b32 v49, v5 offset:9360
  s_waitcnt lgkmcnt(14)
  ds_read_b32 v50, v5 offset:10400
  s_waitcnt lgkmcnt(14)
  ds_read_b64_tr_b16 v[72:73], v2 offset:2464
  s_waitcnt lgkmcnt(14)
  ds_read_b64_tr_b16 v[74:75], v2 offset:2432
  v_mfma_f32_32x32x16_bf16 v[160:175], a[48:51], v[22:25], v[160:175]
  s_waitcnt lgkmcnt(14)
  ds_read_b32 v51, v5 offset:11440
  v_mov_b32 v52, 0
  v_mov_b32 v53, 0
  s_waitcnt lgkmcnt(14)
  ds_read_b64_tr_b16 v[76:77], v2 offset:2592
  s_waitcnt lgkmcnt(14)
  ds_read_b64_tr_b16 v[78:79], v2 offset:2560
  v_mfma_f32_32x32x16_bf16 v[160:175], a[44:47], v[32:35], v[160:175]
  v_mov_b32 v54, 0
  v_mov_b32 v55, 0
  s_waitcnt lgkmcnt(14)
  ds_read_b64_tr_b16 v[36:37], v2 offset:2720
  s_waitcnt lgkmcnt(14)
  ds_read_b64_tr_b16 v[38:39], v2 offset:2688
  v_mfma_f32_32x32x16_bf16 v[160:175], a[40:43], v[64:67], v[160:175]
  s_mov_b64 exec, s[42:43]
  s_waitcnt lgkmcnt(14)
  ds_read_b32 v52, v6 offset:4160
  s_waitcnt lgkmcnt(14)
  ds_read_b32 v53, v6 offset:5200
  s_waitcnt lgkmcnt(14)
  ds_read_b32 v54, v6 offset:6240
  s_waitcnt lgkmcnt(14)
  ds_read_b32 v55, v6 offset:7280
  s_mov_b64 exec, -1
  s_waitcnt lgkmcnt(3)
  v_fmac_f32 v48, s38, v52
  ds_read_b64_tr_b16 v[40:41], v2 offset:2848
  ds_read_b64_tr_b16 v[42:43], v2 offset:2816
  v_mfma_f32_32x32x16_bf16 v[160:175], a[36:39], v[68:71], v[160:175]
  s_waitcnt lgkmcnt(4)
  v_fmac_f32 v49, s38, v53
  s_waitcnt lgkmcnt(3)
  v_fmac_f32 v50, s38, v54
  s_waitcnt lgkmcnt(2)
  v_fmac_f32 v51, s38, v55
  v_cvt_pk_bf16_f32 v56, v48, v49
  ds_read_b64_tr_b16 v[44:45], v2 offset:2976
  ds_read_b64_tr_b16 v[46:47], v2 offset:2944
  v_mfma_f32_32x32x16_bf16 v[160:175], a[32:35], v[72:75], v[160:175]
  v_cvt_pk_bf16_f32 v57, v50, v51
  s_mov_b32 s46, 1310720
  buffer_store_dwordx2 v[56:57], v10, s[12:15], s46 offen
  s_barrier
  s_setprio 0
  ds_read_b64_tr_b16 v[14:15], v2 offset:3104
  ds_read_b64_tr_b16 v[16:17], v2 offset:3072
  v_mfma_f32_32x32x16_bf16 v[160:175], a[28:31], v[76:79], v[160:175]
  ds_read_b32 v48, v5 offset:16640
  ds_read_b32 v49, v5 offset:17680
  ds_read_b32 v50, v5 offset:18720
  ds_read_b32 v51, v5 offset:19760
  v_mov_b32 v52, 0
  v_mov_b32 v53, 0
  ds_read_b64_tr_b16 v[18:19], v2 offset:3232
  ds_read_b64_tr_b16 v[20:21], v2 offset:3200
  v_mfma_f32_32x32x16_bf16 v[160:175], a[24:27], v[36:39], v[160:175]
  v_mov_b32 v54, 0
  v_mov_b32 v55, 0
  s_mov_b64 exec, s[42:43]
  ds_read_b32 v52, v6 offset:12480
  ds_read_b32 v53, v6 offset:13520
  ds_read_b32 v54, v6 offset:14560
  s_waitcnt lgkmcnt(14)
  ds_read_b32 v55, v6 offset:15600
  s_mov_b64 exec, -1
  s_waitcnt lgkmcnt(14)
  ds_read_b64_tr_b16 v[96:97], v2 offset:3360
  s_waitcnt lgkmcnt(14)
  ds_read_b64_tr_b16 v[98:99], v2 offset:3328
  v_mfma_f32_32x32x16_bf16 v[160:175], a[20:23], v[40:43], v[160:175]
  s_waitcnt lgkmcnt(5)
  v_fmac_f32 v48, s38, v52
  s_waitcnt lgkmcnt(4)
  v_fmac_f32 v49, s38, v53
  s_waitcnt lgkmcnt(3)
  v_fmac_f32 v50, s38, v54
  s_waitcnt lgkmcnt(2)
  v_fmac_f32 v51, s38, v55
  v_cvt_pk_bf16_f32 v56, v48, v49
  v_cvt_pk_bf16_f32 v57, v50, v51
  ds_read_b64_tr_b16 v[100:101], v2 offset:3488
  ds_read_b64_tr_b16 v[102:103], v2 offset:3456
  v_mfma_f32_32x32x16_bf16 v[160:175], a[16:19], v[44:47], v[160:175]
  s_mov_b32 s46, 2621440
  buffer_store_dwordx2 v[56:57], v10, s[12:15], s46 offen
  v_mfma_f32_32x32x16_bf16 v[160:175], a[12:15], v[14:17], v[160:175]
  v_mfma_f32_32x32x16_bf16 v[160:175], a[8:11], v[18:21], v[160:175]
  s_waitcnt lgkmcnt(2)
  v_mfma_f32_32x32x16_bf16 v[160:175], a[4:7], v[96:99], v[160:175]
  s_waitcnt lgkmcnt(0)
  v_mfma_f32_32x32x16_bf16 v[160:175], a[0:3], v[100:103], v[160:175]
  s_nop 11
  v_add_f32_dpp v28, v163, v162 wave_shr:1 row_mask:0xf bank_mask:0xf bound_ctrl:0
  s_nop 10
  v_add_f32_dpp v29, v163, v166 wave_ror:1 row_mask:0x1 bank_mask:0x1
  s_nop 9
  v_add_f32_dpp v29, v167, v166 wave_shr:1 row_mask:0xf bank_mask:0xf
  s_nop 8
  v_add_f32_dpp v30, v167, v170 wave_ror:1 row_mask:0x1 bank_mask:0x1
  s_nop 7
  v_add_f32_dpp v30, v171, v170 wave_shr:1 row_mask:0xf bank_mask:0xf
  s_nop 6
  v_add_f32_dpp v26, v171, v174 wave_ror:1 row_mask:0x1 bank_mask:0x1
  s_nop 5
  v_add_f32_dpp v26, v175, v174 wave_shr:1 row_mask:0xf bank_mask:0xf
  s_nop 4
  v_add_f32_dpp v162, v28, v161 wave_shr:1 row_mask:0xf bank_mask:0xf bound_ctrl:0
  s_nop 3
  v_add_f32_dpp v166, v28, v165 wave_ror:1 row_mask:0x1 bank_mask:0x1
  s_nop 2
  v_add_f32_dpp v166, v29, v165 wave_shr:1 row_mask:0xf bank_mask:0xf
  s_nop 1
  v_add_f32_dpp v170, v29, v169 wave_ror:1 row_mask:0x1 bank_mask:0x1
  s_nop 0
  v_add_f32_dpp v170, v30, v169 wave_shr:1 row_mask:0xf bank_mask:0xf
  v_add_f32_dpp v174, v30, v173 wave_ror:1 row_mask:0x1 bank_mask:0x1
  v_add_f32_dpp v174, v26, v173 wave_shr:1 row_mask:0xf bank_mask:0xf
  v_add_f32_dpp v161, v162, v160 wave_shr:1 row_mask:0xf bank_mask:0xf bound_ctrl:0
  v_add_f32_dpp v165, v162, v164 wave_ror:1 row_mask:0x1 bank_mask:0x1
  v_add_f32_dpp v165, v166, v164 wave_shr:1 row_mask:0xf bank_mask:0xf
  v_add_f32_dpp v169, v166, v168 wave_ror:1 row_mask:0x1 bank_mask:0x1
  v_add_f32_dpp v169, v170, v168 wave_shr:1 row_mask:0xf bank_mask:0xf
  v_add_f32_dpp v173, v170, v172 wave_ror:1 row_mask:0x1 bank_mask:0x1
  v_add_f32_dpp v173, v174, v172 wave_shr:1 row_mask:0xf bank_mask:0xf
  s_mov_b32 m0, s47
  s_nop 0
  ds_write_addtid_b32 v161 offset:24960
  ds_write_addtid_b32 v165 offset:25216
  ds_write_addtid_b32 v169 offset:25472
  ds_write_addtid_b32 v173 offset:25728
  s_mov_b64 exec, s[40:41]
  ds_write_addtid_b32 v174 offset:25732
  ds_write_addtid_b32 v26 offset:25736
  ds_write_addtid_b32 v175 offset:25740
  s_mov_b64 exec, -1
  s_waitcnt lgkmcnt(0)
  s_barrier
  s_setprio 2
  ds_read_b32 v48, v5 offset:24960
  ds_read_b32 v49, v5 offset:26000
  ds_read_b32 v50, v5 offset:27040
  ds_read_b32 v51, v5 offset:28080
  v_mov_b32 v52, 0
  v_mov_b32 v53, 0
  v_mov_b32 v54, 0
  v_mov_b32 v55, 0
  s_mov_b64 exec, s[42:43]
  ds_read_b32 v52, v6 offset:20800
  ds_read_b32 v53, v6 offset:21840
  ds_read_b32 v54, v6 offset:22880
  ds_read_b32 v55, v6 offset:23920
  s_mov_b64 exec, -1
  s_waitcnt lgkmcnt(3)
  v_fmac_f32 v48, s38, v52
  s_waitcnt lgkmcnt(2)
  v_fmac_f32 v49, s38, v53
  s_waitcnt lgkmcnt(1)
  v_fmac_f32 v50, s38, v54
  s_waitcnt lgkmcnt(0)
  v_fmac_f32 v51, s38, v55
  v_cvt_pk_bf16_f32 v56, v48, v49
  v_cvt_pk_bf16_f32 v57, v50, v51
  s_mov_b32 s46, 3932160
  buffer_store_dwordx2 v[56:57], v10, s[12:15], s46 offen
  s_branch L_END
L_A_Y:
  s_mov_b32 s20, s52
  s_mov_b32 s21, s53
  s_mov_b32 s48, 2621440
  s_mov_b32 s27, 0
  s_sub_u32 s49, s35, 0
  s_mov_b32 s24, s84
  s_mov_b32 s25, s85
  s_add_u32 s26, s49, 16
  s_mul_i32 s26, s26, 40960
  s_cmp_lt_u32 s49, 48
  s_cselect_b32 s20, s24, s20
  s_cselect_b32 s21, s25, s21
  s_cselect_b32 s48, s26, s48
  s_and_b32 s21, s21, 0xffff
  s_mov_b32 s22, 2621440
  s_mov_b32 s23, 0x20000
  buffer_load_dword v31, v62, s[20:23], s48 offen
  ds_read_b128 a[28:31], v3 offset:224
  ds_read_b128 a[60:63], v3 offset:480
  ds_read_b128 a[24:27], v3 offset:192
  ds_read_b128 a[56:59], v3 offset:448
  ds_read_b128 a[20:23], v3 offset:160
  ds_read_b128 a[52:55], v3 offset:416
  ds_read_b128 a[16:19], v3 offset:128
  ds_read_b128 a[48:51], v3 offset:384
  s_setprio 0
  ds_read_b64_tr_b16 v[32:33], v2 offset:32
  ds_read_b64_tr_b16 v[34:35], v2 offset:0
  ds_read_b64_tr_b16 v[36:37], v2 offset:160
  ds_read_b64_tr_b16 v[38:39], v2 offset:128
  ds_read_b64_tr_b16 v[40:41], v2 offset:288
  ds_read_b64_tr_b16 v[42:43], v2 offset:256
  s_waitcnt lgkmcnt(4)
  v_mfma_f32_32x32x16_bf16 v[80:95], a[28:31], v[32:35], 0
  ds_read_b128 a[12:15], v3 offset:96
  ds_read_b128 a[44:47], v3 offset:352
  v_mfma_f32_32x32x16_bf16 v[112:127], a[60:63], v[32:35], 0
  buffer_load_dwordx2 v[14:15], v63, s[8:11], s34 offen offset:0
  ds_read_b128 a[8:11], v3 offset:64
  ds_read_b128 a[40:43], v3 offset:320
  ds_read_b64_tr_b16 v[44:45], v2 offset:416
  ds_read_b64_tr_b16 v[46:47], v2 offset:384
  s_waitcnt lgkmcnt(8)
  v_mfma_f32_32x32x16_bf16 v[80:95], a[24:27], v[36:39], v[80:95]
  ds_read_b128 a[4:7], v3 offset:32
  ds_read_b128 a[36:39], v3 offset:288
  v_mfma_f32_32x32x16_bf16 v[112:127], a[56:59], v[36:39], v[112:127]
  ds_read_b128 a[0:3], v3 offset:0
  ds_read_b128 a[32:35], v3 offset:256
  ds_read_b64_tr_b16 v[176:177], v2 offset:544
  ds_read_b64_tr_b16 v[178:179], v2 offset:512
  s_waitcnt lgkmcnt(12)
  v_mfma_f32_32x32x16_bf16 v[80:95], a[20:23], v[40:43], v[80:95]
  ds_read_b128 v[108:111], v3 offset:736
  ds_read_b128 v[104:107], v3 offset:704
  v_mfma_f32_32x32x16_bf16 v[112:127], a[52:55], v[40:43], v[112:127]
  buffer_load_dwordx2 v[16:17], v63, s[8:11], s34 offen offset:1280
  ds_read_b128 v[100:103], v3 offset:672
  s_waitcnt lgkmcnt(14)
  ds_read_b128 v[96:99], v3 offset:640
  s_waitcnt lgkmcnt(14)
  ds_read_b64_tr_b16 v[180:181], v2 offset:672
  s_waitcnt lgkmcnt(14)
  ds_read_b64_tr_b16 v[182:183], v2 offset:640
  s_waitcnt lgkmcnt(12)
  v_mfma_f32_32x32x16_bf16 v[80:95], a[16:19], v[44:47], v[80:95]
  ds_read_b128 v[76:79], v3 offset:608
  ds_read_b128 v[72:75], v3 offset:576
  v_mfma_f32_32x32x16_bf16 v[112:127], a[48:51], v[44:47], v[112:127]
  ds_read_b128 v[68:71], v3 offset:544
  s_waitcnt lgkmcnt(14)
  ds_read_b128 v[64:67], v3 offset:512
  s_waitcnt lgkmcnt(14)
  ds_read_b64_tr_b16 v[184:185], v2 offset:800
  s_waitcnt lgkmcnt(14)
  ds_read_b64_tr_b16 v[186:187], v2 offset:768
  s_waitcnt lgkmcnt(12)
  v_mfma_f32_32x32x16_bf16 v[80:95], a[12:15], v[176:179], v[80:95]
  ds_read_b128 v[172:175], v3 offset:992
  ds_read_b128 v[168:171], v3 offset:960
  v_mfma_f32_32x32x16_bf16 v[112:127], a[44:47], v[176:179], v[112:127]
  buffer_load_dwordx2 v[18:19], v63, s[8:11], s34 offen offset:2560
  ds_read_b128 v[164:167], v3 offset:928
  s_waitcnt lgkmcnt(14)
  ds_read_b128 v[160:163], v3 offset:896
  s_waitcnt lgkmcnt(14)
  ds_read_b64_tr_b16 v[188:189], v2 offset:928
  s_waitcnt lgkmcnt(14)
  ds_read_b64_tr_b16 v[190:191], v2 offset:896
  s_waitcnt lgkmcnt(12)
  v_mfma_f32_32x32x16_bf16 v[80:95], a[8:11], v[180:183], v[80:95]
  ds_read_b128 v[140:143], v3 offset:864
  ds_read_b128 v[136:139], v3 offset:832
  v_mfma_f32_32x32x16_bf16 v[112:127], a[40:43], v[180:183], v[112:127]
  ds_read_b128 v[132:135], v3 offset:800
  s_waitcnt lgkmcnt(14)
  ds_read_b128 v[128:131], v3 offset:768
  s_waitcnt lgkmcnt(14)
  ds_read_b64_tr_b16 v[32:33], v2 offset:1056
  s_waitcnt lgkmcnt(14)
  ds_read_b64_tr_b16 v[34:35], v2 offset:1024
  s_waitcnt lgkmcnt(12)
  v_mfma_f32_32x32x16_bf16 v[80:95], a[4:7], v[184:187], v[80:95]
  v_mfma_f32_32x32x16_bf16 v[112:127], a[36:39], v[184:187], v[112:127]
  buffer_load_dwordx2 v[20:21], v63, s[8:11], s34 offen offset:3840
  ds_read_b64_tr_b16 v[36:37], v2 offset:1184
  ds_read_b64_tr_b16 v[38:39], v2 offset:1152
  ds_read_b64_tr_b16 v[40:41], v2 offset:1312
  s_waitcnt lgkmcnt(14)
  ds_read_b64_tr_b16 v[42:43], v2 offset:1280
  s_waitcnt lgkmcnt(10)
  v_mfma_f32_32x32x16_bf16 v[80:95], a[0:3], v[188:191], v[80:95]
  v_mfma_f32_32x32x16_bf16 v[112:127], a[32:35], v[188:191], v[112:127]
  s_barrier
  s_setprio 2
  ds_read_b64_tr_b16 v[44:45], v2 offset:1440
  ds_read_b64_tr_b16 v[46:47], v2 offset:1408
  ds_read_b64_tr_b16 v[176:177], v2 offset:1568
  ds_read_b64_tr_b16 v[178:179], v2 offset:1536
  s_waitcnt lgkmcnt(8)
  v_mfma_f32_32x32x16_bf16 v[112:127], a[28:31], v[32:35], v[112:127]
  s_nop 2
  v_add_f32_dpp v28, v83, v82 wave_shr:1 row_mask:0xf bank_mask:0xf bound_ctrl:0
  s_nop 1
  v_add_f32_dpp v29, v83, v86 wave_ror:1 row_mask:0x1 bank_mask:0x1
  s_nop 0
  v_add_f32_dpp v29, v87, v86 wave_shr:1 row_mask:0xf bank_mask:0xf
  ds_read_b64_tr_b16 v[180:181], v2 offset:1696
  ds_read_b64_tr_b16 v[182:183], v2 offset:1664
  s_waitcnt lgkmcnt(8)
  v_mfma_f32_32x32x16_bf16 v[112:127], a[24:27], v[36:39], v[112:127]
  v_add_f32_dpp v30, v87, v90 wave_ror:1 row_mask:0x1 bank_mask:0x1
  v_add_f32_dpp v30, v91, v90 wave_shr:1 row_mask:0xf bank_mask:0xf
  v_add_f32_dpp v27, v91, v94 wave_ror:1 row_mask:0x1 bank_mask:0x1
  v_add_f32_dpp v27, v95, v94 wave_shr:1 row_mask:0xf bank_mask:0xf
  ds_read_b64_tr_b16 v[184:185], v2 offset:1824
  ds_read_b64_tr_b16 v[186:187], v2 offset:1792
  s_waitcnt lgkmcnt(8)
  v_mfma_f32_32x32x16_bf16 v[112:127], a[20:23], v[40:43], v[112:127]
  v_add_f32_dpp v82, v28, v81 wave_shr:1 row_mask:0xf bank_mask:0xf bound_ctrl:0
  v_add_f32_dpp v86, v28, v85 wave_ror:1 row_mask:0x1 bank_mask:0x1
  v_add_f32_dpp v86, v29, v85 wave_shr:1 row_mask:0xf bank_mask:0xf
  ds_read_b64_tr_b16 v[188:189], v2 offset:1952
  ds_read_b64_tr_b16 v[190:191], v2 offset:1920
  s_waitcnt lgkmcnt(8)
  v_mfma_f32_32x32x16_bf16 v[112:127], a[16:19], v[44:47], v[112:127]
  v_add_f32_dpp v90, v29, v89 wave_ror:1 row_mask:0x1 bank_mask:0x1
  v_add_f32_dpp v90, v30, v89 wave_shr:1 row_mask:0xf bank_mask:0xf
  v_add_f32_dpp v94, v30, v93 wave_ror:1 row_mask:0x1 bank_mask:0x1
  v_add_f32_dpp v94, v27, v93 wave_shr:1 row_mask:0xf bank_mask:0xf
  ds_read_b64_tr_b16 v[32:33], v2 offset:32
  ds_read_b64_tr_b16 v[34:35], v2 offset:0
  s_waitcnt lgkmcnt(8)
  v_mfma_f32_32x32x16_bf16 v[112:127], a[12:15], v[176:179], v[112:127]
  v_add_f32_dpp v81, v82, v80 wave_shr:1 row_mask:0xf bank_mask:0xf bound_ctrl:0
  v_add_f32_dpp v85, v82, v84 wave_ror:1 row_mask:0x1 bank_mask:0x1
  v_add_f32_dpp v85, v86, v84 wave_shr:1 row_mask:0xf bank_mask:0xf
  ds_read_b64_tr_b16 v[36:37], v2 offset:160
  ds_read_b64_tr_b16 v[38:39], v2 offset:128
  s_waitcnt lgkmcnt(8)
  v_mfma_f32_32x32x16_bf16 v[112:127], a[8:11], v[180:183], v[112:127]
  v_add_f32_dpp v89, v86, v88 wave_ror:1 row_mask:0x1 bank_mask:0x1
  v_add_f32_dpp v89, v90, v88 wave_shr:1 row_mask:0xf bank_mask:0xf
  v_add_f32_dpp v93, v90, v92 wave_ror:1 row_mask:0x1 bank_mask:0x1
  v_add_f32_dpp v93, v94, v92 wave_shr:1 row_mask:0xf bank_mask:0xf
  ds_read_b64_tr_b16 v[40:41], v2 offset:288
  ds_read_b64_tr_b16 v[42:43], v2 offset:256
  s_waitcnt lgkmcnt(8)
  v_mfma_f32_32x32x16_bf16 v[112:127], a[4:7], v[184:187], v[112:127]
  s_mov_b32 m0, s47
  s_nop 0
  ds_write_addtid_b32 v81 offset:4160
  ds_write_addtid_b32 v85 offset:4416
  ds_write_addtid_b32 v89 offset:4672
  ds_write_addtid_b32 v93 offset:4928
  ds_read_b64_tr_b16 v[44:45], v2 offset:416
  ds_read_b64_tr_b16 v[46:47], v2 offset:384
  s_waitcnt lgkmcnt(12)
  v_mfma_f32_32x32x16_bf16 v[112:127], a[0:3], v[188:191], v[112:127]
  s_mov_b64 exec, s[40:41]
  ds_write_addtid_b32 v94 offset:4932
  ds_write_addtid_b32 v27 offset:4936
  ds_write_addtid_b32 v95 offset:4940
  s_mov_b64 exec, -1
  s_waitcnt lgkmcnt(14)
  ds_read_b64_tr_b16 v[176:177], v2 offset:544
  s_waitcnt lgkmcnt(14)
  ds_read_b64_tr_b16 v[178:179], v2 offset:512
  v_mfma_f32_32x32x16_bf16 v[144:159], v[108:111], v[32:35], 0
  s_nop 1
  v_add_f32_dpp v28, v115, v114 wave_shr:1 row_mask:0xf bank_mask:0xf bound_ctrl:0
  s_nop 0
  v_add_f32_dpp v29, v115, v118 wave_ror:1 row_mask:0x1 bank_mask:0x1
  v_add_f32_dpp v29, v119, v118 wave_shr:1 row_mask:0xf bank_mask:0xf
  s_waitcnt lgkmcnt(14)
  ds_read_b64_tr_b16 v[180:181], v2 offset:672
  s_waitcnt lgkmcnt(14)
  ds_read_b64_tr_b16 v[182:183], v2 offset:640
  v_mfma_f32_32x32x16_bf16 v[144:159], v[104:107], v[36:39], v[144:159]
  v_add_f32_dpp v30, v119, v122 wave_ror:1 row_mask:0x1 bank_mask:0x1
  v_add_f32_dpp v30, v123, v122 wave_shr:1 row_mask:0xf bank_mask:0xf
  v_add_f32_dpp v27, v123, v126 wave_ror:1 row_mask:0x1 bank_mask:0x1
  v_add_f32_dpp v27, v127, v126 wave_shr:1 row_mask:0xf bank_mask:0xf
  s_waitcnt lgkmcnt(14)
  ds_read_b64_tr_b16 v[184:185], v2 offset:800
  s_waitcnt lgkmcnt(14)
  ds_read_b64_tr_b16 v[186:187], v2 offset:768
  v_mfma_f32_32x32x16_bf16 v[144:159], v[100:103], v[40:43], v[144:159]
  v_add_f32_dpp v114, v28, v113 wave_shr:1 row_mask:0xf bank_mask:0xf bound_ctrl:0
  v_add_f32_dpp v118, v28, v117 wave_ror:1 row_mask:0x1 bank_mask:0x1
  v_add_f32_dpp v118, v29, v117 wave_shr:1 row_mask:0xf bank_mask:0xf
  s_waitcnt lgkmcnt(14)
  ds_read_b64_tr_b16 v[188:189], v2 offset:928
  s_waitcnt lgkmcnt(14)
  ds_read_b64_tr_b16 v[190:191], v2 offset:896
  s_waitcnt lgkmcnt(11)
  v_mfma_f32_32x32x16_bf16 v[144:159], v[96:99], v[44:47], v[144:159]
  v_add_f32_dpp v122, v29, v121 wave_ror:1 row_mask:0x1 bank_mask:0x1
  v_add_f32_dpp v122, v30, v121 wave_shr:1 row_mask:0xf bank_mask:0xf
  ds_read_b64_tr_b16 v[32:33], v2 offset:1056
  ds_read_b64_tr_b16 v[34:35], v2 offset:1024
  s_waitcnt lgkmcnt(8)
  v_mfma_f32_32x32x16_bf16 v[144:159], v[76:79], v[176:179], v[144:159]
  v_add_f32_dpp v126, v30, v125 wave_ror:1 row_mask:0x1 bank_mask:0x1
  v_add_f32_dpp v126, v27, v125 wave_shr:1 row_mask:0xf bank_mask:0xf
  v_add_f32_dpp v113, v114, v112 wave_shr:1 row_mask:0xf bank_mask:0xf bound_ctrl:0
  v_add_f32_dpp v117, v114, v116 wave_ror:1 row_mask:0x1 bank_mask:0x1
  v_add_f32_dpp v117, v118, v116 wave_shr:1 row_mask:0xf bank_mask:0xf
  ds_read_b64_tr_b16 v[36:37], v2 offset:1184
  ds_read_b64_tr_b16 v[38:39], v2 offset:1152
  s_waitcnt lgkmcnt(8)
  v_mfma_f32_32x32x16_bf16 v[144:159], v[72:75], v[180:183], v[144:159]
  v_add_f32_dpp v121, v118, v120 wave_ror:1 row_mask:0x1 bank_mask:0x1
  v_add_f32_dpp v121, v122, v120 wave_shr:1 row_mask:0xf bank_mask:0xf
  ds_read_b64_tr_b16 v[40:41], v2 offset:1312
  ds_read_b64_tr_b16 v[42:43], v2 offset:1280
  s_waitcnt lgkmcnt(8)
  v_mfma_f32_32x32x16_bf16 v[144:159], v[68:71], v[184:187], v[144:159]
  v_add_f32_dpp v125, v122, v124 wave_ror:1 row_mask:0x1 bank_mask:0x1
  v_add_f32_dpp v125, v126, v124 wave_shr:1 row_mask:0xf bank_mask:0xf
  s_mov_b32 m0, s47
  s_nop 0
  ds_write_addtid_b32 v113 offset:12480
  ds_write_addtid_b32 v117 offset:12736
  ds_write_addtid_b32 v121 offset:12992
  ds_write_addtid_b32 v125 offset:13248
  ds_read_b64_tr_b16 v[44:45], v2 offset:1440
  ds_read_b64_tr_b16 v[46:47], v2 offset:1408
  s_waitcnt lgkmcnt(12)
  v_mfma_f32_32x32x16_bf16 v[144:159], v[64:67], v[188:191], v[144:159]
  s_waitcnt lgkmcnt(10)
  v_mfma_f32_32x32x16_bf16 v[144:159], a[60:63], v[32:35], v[144:159]
  s_mov_b64 exec, s[40:41]
  ds_write_addtid_b32 v126 offset:13252
  ds_write_addtid_b32 v27 offset:13256
  ds_write_addtid_b32 v127 offset:13260
  s_mov_b64 exec, -1
  s_waitcnt vmcnt(2)
  v_perm_b32 v22, v16, v14, s32
  s_waitcnt vmcnt(0)
  v_perm_b32 v23, v20, v18, s32
  ds_read_b64_tr_b16 v[32:33], v2 offset:1568
  ds_read_b64_tr_b16 v[34:35], v2 offset:1536
  s_waitcnt lgkmcnt(13)
  v_mfma_f32_32x32x16_bf16 v[144:159], a[56:59], v[36:39], v[144:159]
  ds_write_b64 v9, v[22:23] offset:0
  v_perm_b32 v24, v16, v14, s33
  v_perm_b32 v25, v20, v18, s33
  ds_read_b64_tr_b16 v[36:37], v2 offset:1696
  s_waitcnt lgkmcnt(14)
  ds_read_b64_tr_b16 v[38:39], v2 offset:1664
  s_waitcnt lgkmcnt(14)
  v_mfma_f32_32x32x16_bf16 v[144:159], a[52:55], v[40:43], v[144:159]
  ds_write_b64 v9, v[24:25] offset:4176
  v_perm_b32 v22, v17, v15, s32
  v_perm_b32 v23, v21, v19, s32
  s_waitcnt lgkmcnt(14)
  ds_write_b64 v9, v[22:23] offset:8352
  s_waitcnt lgkmcnt(14)
  ds_read_b64_tr_b16 v[40:41], v2 offset:1824
  s_waitcnt lgkmcnt(14)
  ds_read_b64_tr_b16 v[42:43], v2 offset:1792
  s_waitcnt lgkmcnt(12)
  v_mfma_f32_32x32x16_bf16 v[144:159], a[48:51], v[44:47], v[144:159]
  v_perm_b32 v24, v17, v15, s33
  v_perm_b32 v25, v21, v19, s33
  ds_write_b64 v9, v[24:25] offset:12528
  s_waitcnt lgkmcnt(0)
  s_barrier
  s_setprio 2
  ds_read_b64_tr_b16 v[44:45], v2 offset:1952
  ds_read_b64_tr_b16 v[46:47], v2 offset:1920
  ds_read_b64_tr_b16 v[14:15], v2 offset:2080
  ds_read_b64_tr_b16 v[16:17], v2 offset:2048
  v_mfma_f32_32x32x16_bf16 v[144:159], a[44:47], v[32:35], v[144:159]
  ds_read_b32 v48, v5 offset:12480
  ds_read_b32 v49, v5 offset:13520
  ds_read_b64_tr_b16 v[18:19], v2 offset:2208
  ds_read_b64_tr_b16 v[20:21], v2 offset:2176
  v_mfma_f32_32x32x16_bf16 v[144:159], a[40:43], v[36:39], v[144:159]
  ds_read_b32 v50, v5 offset:14560
  ds_read_b32 v51, v5 offset:15600
  v_mov_b32 v52, 0
  ds_read_b64_tr_b16 v[22:23], v2 offset:2336
  ds_read_b64_tr_b16 v[24:25], v2 offset:2304
  v_mfma_f32_32x32x16_bf16 v[144:159], a[36:39], v[40:43], v[144:159]
  v_mov_b32 v53, 0
  v_mov_b32 v54, 0
  ds_read_b64_tr_b16 v[80:81], v2 offset:2464
  ds_read_b64_tr_b16 v[82:83], v2 offset:2432
  s_waitcnt lgkmcnt(12)
  v_mfma_f32_32x32x16_bf16 v[144:159], a[32:35], v[44:47], v[144:159]
  v_mov_b32 v55, 0
  ds_read_b64_tr_b16 v[84:85], v2 offset:2592
  ds_read_b64_tr_b16 v[86:87], v2 offset:2560
  s_waitcnt lgkmcnt(12)
  v_mfma_f32_32x32x16_bf16 v[144:159], a[28:31], v[14:17], v[144:159]
  s_mov_b64 exec, s[42:43]
  ds_read_b32 v52, v6 offset:8320
  ds_read_b32 v53, v6 offset:9360
  ds_read_b32 v54, v6 offset:10400
  s_waitcnt lgkmcnt(14)
  ds_read_b32 v55, v6 offset:11440
  s_mov_b64 exec, -1
  s_waitcnt lgkmcnt(14)
  ds_read_b64_tr_b16 v[88:89], v2 offset:2720
  s_waitcnt lgkmcnt(14)
  ds_read_b64_tr_b16 v[90:91], v2 offset:2688
  s_waitcnt lgkmcnt(14)
  v_mfma_f32_32x32x16_bf16 v[144:159], a[24:27], v[18:21], v[144:159]
  s_waitcnt lgkmcnt(5)
  v_fmac_f32 v48, s38, v52
  s_waitcnt lgkmcnt(4)
  v_fmac_f32 v49, s38, v53
  ds_read_b64_tr_b16 v[92:93], v2 offset:2848
  ds_read_b64_tr_b16 v[94:95], v2 offset:2816
  v_mfma_f32_32x32x16_bf16 v[144:159], a[20:23], v[22:25], v[144:159]
  s_waitcnt lgkmcnt(5)
  v_fmac_f32 v50, s38, v54
  s_waitcnt lgkmcnt(4)
  v_fmac_f32 v51, s38, v55
  v_cvt_pk_bf16_f32 v56, v48, v49
  ds_read_b64_tr_b16 v[112:113], v2 offset:2976
  ds_read_b64_tr_b16 v[114:115], v2 offset:2944
  v_mfma_f32_32x32x16_bf16 v[144:159], a[16:19], v[80:83], v[144:159]
  v_cvt_pk_bf16_f32 v57, v50, v51
  s_mov_b32 s46, 1966080
  buffer_store_dwordx2 v[56:57], v10, s[12:15], s46 offen
  ds_read_b64_tr_b16 v[116:117], v2 offset:32
  ds_read_b64_tr_b16 v[118:119], v2 offset:0
  v_mfma_f32_32x32x16_bf16 v[144:159], a[12:15], v[84:87], v[144:159]
  ds_read_b64_tr_b16 v[120:121], v2 offset:160
  ds_read_b64_tr_b16 v[122:123], v2 offset:128
  s_waitcnt lgkmcnt(8)
  v_mfma_f32_32x32x16_bf16 v[144:159], a[8:11], v[88:91], v[144:159]
  ds_read_b64_tr_b16 v[124:125], v2 offset:288
  ds_read_b64_tr_b16 v[126:127], v2 offset:256
  s_waitcnt lgkmcnt(8)
  v_mfma_f32_32x32x16_bf16 v[144:159], a[4:7], v[92:95], v[144:159]
  ds_read_b64_tr_b16 v[32:33], v2 offset:416
  ds_read_b64_tr_b16 v[34:35], v2 offset:384
  s_waitcnt lgkmcnt(8)
  v_mfma_f32_32x32x16_bf16 v[144:159], a[0:3], v[112:115], v[144:159]
  s_nop 11
  v_add_f32_dpp v28, v147, v146 wave_shr:1 row_mask:0xf bank_mask:0xf bound_ctrl:0
  s_nop 10
  v_add_f32_dpp v29, v147, v150 wave_ror:1 row_mask:0x1 bank_mask:0x1
  s_nop 9
  v_add_f32_dpp v29, v151, v150 wave_shr:1 row_mask:0xf bank_mask:0xf
  s_nop 8
  v_add_f32_dpp v30, v151, v154 wave_ror:1 row_mask:0x1 bank_mask:0x1
  s_nop 7
  v_add_f32_dpp v30, v155, v154 wave_shr:1 row_mask:0xf bank_mask:0xf
  s_nop 6
  v_add_f32_dpp v27, v155, v158 wave_ror:1 row_mask:0x1 bank_mask:0x1
  s_nop 5
  v_add_f32_dpp v27, v159, v158 wave_shr:1 row_mask:0xf bank_mask:0xf
  s_nop 4
  v_add_f32_dpp v146, v28, v145 wave_shr:1 row_mask:0xf bank_mask:0xf bound_ctrl:0
  ds_read_b64_tr_b16 v[36:37], v2 offset:544
  ds_read_b64_tr_b16 v[38:39], v2 offset:512
  s_waitcnt lgkmcnt(8)
  v_mfma_f32_32x32x16_bf16 v[176:191], v[172:175], v[116:119], 0
  v_add_f32_dpp v150, v28, v149 wave_ror:1 row_mask:0x1 bank_mask:0x1
  v_add_f32_dpp v150, v29, v149 wave_shr:1 row_mask:0xf bank_mask:0xf
  v_add_f32_dpp v154, v29, v153 wave_ror:1 row_mask:0x1 bank_mask:0x1
  v_add_f32_dpp v154, v30, v153 wave_shr:1 row_mask:0xf bank_mask:0xf
  ds_read_b64_tr_b16 v[40:41], v2 offset:672
  ds_read_b64_tr_b16 v[42:43], v2 offset:640
  s_waitcnt lgkmcnt(8)
  v_mfma_f32_32x32x16_bf16 v[176:191], v[168:171], v[120:123], v[176:191]
  v_add_f32_dpp v158, v30, v157 wave_ror:1 row_mask:0x1 bank_mask:0x1
  v_add_f32_dpp v158, v27, v157 wave_shr:1 row_mask:0xf bank_mask:0xf
  ds_read_b64_tr_b16 v[44:45], v2 offset:800
  ds_read_b64_tr_b16 v[46:47], v2 offset:768
  s_waitcnt lgkmcnt(8)
  v_mfma_f32_32x32x16_bf16 v[176:191], v[164:167], v[124:127], v[176:191]
  v_add_f32_dpp v145, v146, v144 wave_shr:1 row_mask:0xf bank_mask:0xf bound_ctrl:0
  v_add_f32_dpp v149, v146, v148 wave_ror:1 row_mask:0x1 bank_mask:0x1
  v_add_f32_dpp v149, v150, v148 wave_shr:1 row_mask:0xf bank_mask:0xf
  ds_read_b64_tr_b16 v[14:15], v2 offset:928
  ds_read_b64_tr_b16 v[16:17], v2 offset:896
  s_waitcnt lgkmcnt(8)
  v_mfma_f32_32x32x16_bf16 v[176:191], v[160:163], v[32:35], v[176:191]
  v_add_f32_dpp v153, v150, v152 wave_ror:1 row_mask:0x1 bank_mask:0x1
  v_add_f32_dpp v153, v154, v152 wave_shr:1 row_mask:0xf bank_mask:0xf
  ds_read_b64_tr_b16 v[18:19], v2 offset:1056
  ds_read_b64_tr_b16 v[20:21], v2 offset:1024
  s_waitcnt lgkmcnt(8)
  v_mfma_f32_32x32x16_bf16 v[176:191], v[140:143], v[36:39], v[176:191]
  v_add_f32_dpp v157, v154, v156 wave_ror:1 row_mask:0x1 bank_mask:0x1
  v_add_f32_dpp v157, v158, v156 wave_shr:1 row_mask:0xf bank_mask:0xf
  ds_read_b64_tr_b16 v[22:23], v2 offset:1184
  ds_read_b64_tr_b16 v[24:25], v2 offset:1152
  s_waitcnt lgkmcnt(8)
  v_mfma_f32_32x32x16_bf16 v[176:191], v[136:139], v[40:43], v[176:191]
  s_mov_b32 m0, s47
  s_nop 0
  ds_write_addtid_b32 v145 offset:20800
  ds_write_addtid_b32 v149 offset:21056
  ds_write_addtid_b32 v153 offset:21312
  ds_write_addtid_b32 v157 offset:21568
  ds_read_b64_tr_b16 v[80:81], v2 offset:1312
  ds_read_b64_tr_b16 v[82:83], v2 offset:1280
  s_waitcnt lgkmcnt(12)
  v_mfma_f32_32x32x16_bf16 v[176:191], v[132:135], v[44:47], v[176:191]
  ds_read_b64_tr_b16 v[84:85], v2 offset:1440
  ds_read_b64_tr_b16 v[86:87], v2 offset:1408
  s_waitcnt lgkmcnt(12)
  v_mfma_f32_32x32x16_bf16 v[176:191], v[128:131], v[14:17], v[176:191]
  s_mov_b64 exec, s[40:41]
  ds_write_addtid_b32 v158 offset:21572
  ds_write_addtid_b32 v27 offset:21576
  ds_write_addtid_b32 v159 offset:21580
  s_mov_b64 exec, -1
  s_waitcnt lgkmcnt(0)
  s_barrier
  s_setprio 2
  ds_read_b64_tr_b16 v[88:89], v2 offset:1568
  ds_read_b64_tr_b16 v[90:91], v2 offset:1536
  v_mfma_f32_32x32x16_bf16 v[176:191], v[108:111], v[18:21], v[176:191]
  ds_read_b32 v48, v5 offset:20800
  ds_read_b32 v49, v5 offset:21840
  ds_read_b64_tr_b16 v[92:93], v2 offset:1696
  ds_read_b64_tr_b16 v[94:95], v2 offset:1664
  v_mfma_f32_32x32x16_bf16 v[176:191], v[104:107], v[22:25], v[176:191]
  ds_read_b32 v50, v5 offset:22880
  ds_read_b32 v51, v5 offset:23920
  ds_read_b64_tr_b16 v[112:113], v2 offset:1824
  ds_read_b64_tr_b16 v[114:115], v2 offset:1792
  v_mfma_f32_32x32x16_bf16 v[176:191], v[100:103], v[80:83], v[176:191]
  v_mov_b32 v52, 0
  v_mov_b32 v53, 0
  ds_read_b64_tr_b16 v[116:117], v2 offset:1952
  ds_read_b64_tr_b16 v[118:119], v2 offset:1920
  v_mfma_f32_32x32x16_bf16 v[176:191], v[96:99], v[84:87], v[176:191]
  v_mov_b32 v54, 0
  v_mov_b32 v55, 0
  ds_read_b64_tr_b16 v[120:121], v2 offset:2080
  ds_read_b64_tr_b16 v[122:123], v2 offset:2048
  s_waitcnt lgkmcnt(12)
  v_mfma_f32_32x32x16_bf16 v[176:191], v[76:79], v[88:91], v[176:191]
  s_mov_b64 exec, s[42:43]
  ds_read_b32 v52, v6 offset:16640
  ds_read_b32 v53, v6 offset:17680
  ds_read_b32 v54, v6 offset:18720
  s_waitcnt lgkmcnt(14)
  ds_read_b32 v55, v6 offset:19760
  s_mov_b64 exec, -1
  s_waitcnt lgkmcnt(14)
  ds_read_b64_tr_b16 v[124:125], v2 offset:2208
  s_waitcnt lgkmcnt(14)
  ds_read_b64_tr_b16 v[126:127], v2 offset:2176
  s_waitcnt lgkmcnt(14)
  v_mfma_f32_32x32x16_bf16 v[176:191], v[72:75], v[92:95], v[176:191]
  ds_read_b64_tr_b16 v[32:33], v2 offset:2336
  s_waitcnt lgkmcnt(14)
  ds_read_b64_tr_b16 v[34:35], v2 offset:2304
  s_waitcnt lgkmcnt(12)
  v_mfma_f32_32x32x16_bf16 v[176:191], v[68:71], v[112:115], v[176:191]
  s_waitcnt lgkmcnt(7)
  v_fmac_f32 v48, s38, v52
  s_waitcnt lgkmcnt(6)
  v_fmac_f32 v49, s38, v53
  ds_read_b64_tr_b16 v[36:37], v2 offset:2464
  ds_read_b64_tr_b16 v[38:39], v2 offset:2432
  v_mfma_f32_32x32x16_bf16 v[176:191], v[64:67], v[116:119], v[176:191]
  s_waitcnt lgkmcnt(7)
  v_fmac_f32 v50, s38, v54
  s_waitcnt lgkmcnt(6)
  v_fmac_f32 v51, s38, v55
  ds_read_b64_tr_b16 v[40:41], v2 offset:2592
  ds_read_b64_tr_b16 v[42:43], v2 offset:2560
  v_mfma_f32_32x32x16_bf16 v[176:191], a[60:63], v[120:123], v[176:191]
  v_cvt_pk_bf16_f32 v56, v48, v49
  v_cvt_pk_bf16_f32 v57, v50, v51
  ds_read_b64_tr_b16 v[44:45], v2 offset:2720
  ds_read_b64_tr_b16 v[46:47], v2 offset:2688
  s_waitcnt lgkmcnt(8)
  v_mfma_f32_32x32x16_bf16 v[176:191], a[56:59], v[124:127], v[176:191]
  s_mov_b32 s46, 3276800
  buffer_store_dwordx2 v[56:57], v10, s[12:15], s46 offen
  ds_read_b64_tr_b16 v[14:15], v2 offset:2848
  ds_read_b64_tr_b16 v[16:17], v2 offset:2816
  s_waitcnt lgkmcnt(8)
  v_mfma_f32_32x32x16_bf16 v[176:191], a[52:55], v[32:35], v[176:191]
  ds_read_b64_tr_b16 v[18:19], v2 offset:2976
  ds_read_b64_tr_b16 v[20:21], v2 offset:2944
  s_waitcnt lgkmcnt(8)
  v_mfma_f32_32x32x16_bf16 v[176:191], a[48:51], v[36:39], v[176:191]
  ds_read_b64_tr_b16 v[22:23], v2 offset:3104
  ds_read_b64_tr_b16 v[24:25], v2 offset:3072
  s_waitcnt lgkmcnt(8)
  v_mfma_f32_32x32x16_bf16 v[176:191], a[44:47], v[40:43], v[176:191]
  ds_read_b64_tr_b16 v[80:81], v2 offset:3232
  ds_read_b64_tr_b16 v[82:83], v2 offset:3200
  s_waitcnt lgkmcnt(8)
  v_mfma_f32_32x32x16_bf16 v[176:191], a[40:43], v[44:47], v[176:191]
  ds_read_b64_tr_b16 v[84:85], v2 offset:3360
  ds_read_b64_tr_b16 v[86:87], v2 offset:3328
  s_waitcnt lgkmcnt(8)
  v_mfma_f32_32x32x16_bf16 v[176:191], a[36:39], v[14:17], v[176:191]
  ds_read_b64_tr_b16 v[88:89], v2 offset:3488
  ds_read_b64_tr_b16 v[90:91], v2 offset:3456
  s_waitcnt lgkmcnt(8)
  v_mfma_f32_32x32x16_bf16 v[176:191], a[32:35], v[18:21], v[176:191]
  ds_read_b64_tr_b16 v[92:93], v2 offset:3616
  ds_read_b64_tr_b16 v[94:95], v2 offset:3584
  s_waitcnt lgkmcnt(8)
  v_mfma_f32_32x32x16_bf16 v[176:191], a[28:31], v[22:25], v[176:191]
  ds_read_b64_tr_b16 v[112:113], v2 offset:3744
  ds_read_b64_tr_b16 v[114:115], v2 offset:3712
  s_waitcnt lgkmcnt(8)
  v_mfma_f32_32x32x16_bf16 v[176:191], a[24:27], v[80:83], v[176:191]
  ds_read_b64_tr_b16 v[116:117], v2 offset:3872
  ds_read_b64_tr_b16 v[118:119], v2 offset:3840
  s_waitcnt lgkmcnt(8)
  v_mfma_f32_32x32x16_bf16 v[176:191], a[20:23], v[84:87], v[176:191]
  ds_read_b64_tr_b16 v[120:121], v2 offset:4000
  ds_read_b64_tr_b16 v[122:123], v2 offset:3968
  s_waitcnt lgkmcnt(8)
  v_mfma_f32_32x32x16_bf16 v[176:191], a[16:19], v[88:91], v[176:191]
  s_waitcnt lgkmcnt(6)
  v_mfma_f32_32x32x16_bf16 v[176:191], a[12:15], v[92:95], v[176:191]
  s_waitcnt lgkmcnt(4)
  v_mfma_f32_32x32x16_bf16 v[176:191], a[8:11], v[112:115], v[176:191]
  s_waitcnt lgkmcnt(2)
  v_mfma_f32_32x32x16_bf16 v[176:191], a[4:7], v[116:119], v[176:191]
  s_waitcnt lgkmcnt(0)
  v_mfma_f32_32x32x16_bf16 v[176:191], a[0:3], v[120:123], v[176:191]
  s_nop 11
  v_add_f32_dpp v28, v179, v178 wave_shr:1 row_mask:0xf bank_mask:0xf bound_ctrl:0
  s_nop 10
  v_add_f32_dpp v29, v179, v182 wave_ror:1 row_mask:0x1 bank_mask:0x1
  s_nop 9
  v_add_f32_dpp v29, v183, v182 wave_shr:1 row_mask:0xf bank_mask:0xf
  s_nop 8
  v_add_f32_dpp v30, v183, v186 wave_ror:1 row_mask:0x1 bank_mask:0x1
  s_nop 7
  v_add_f32_dpp v30, v187, v186 wave_shr:1 row_mask:0xf bank_mask:0xf
  s_nop 6
  v_add_f32_dpp v27, v187, v190 wave_ror:1 row_mask:0x1 bank_mask:0x1
  s_nop 5
  v_add_f32_dpp v27, v191, v190 wave_shr:1 row_mask:0xf bank_mask:0xf
  s_nop 4
  v_add_f32_dpp v178, v28, v177 wave_shr:1 row_mask:0xf bank_mask:0xf bound_ctrl:0
  s_nop 3
  v_add_f32_dpp v182, v28, v181 wave_ror:1 row_mask:0x1 bank_mask:0x1
  s_nop 2
  v_add_f32_dpp v182, v29, v181 wave_shr:1 row_mask:0xf bank_mask:0xf
  s_nop 1
  v_add_f32_dpp v186, v29, v185 wave_ror:1 row_mask:0x1 bank_mask:0x1
  s_nop 0
  v_add_f32_dpp v186, v30, v185 wave_shr:1 row_mask:0xf bank_mask:0xf
  v_add_f32_dpp v190, v30, v189 wave_ror:1 row_mask:0x1 bank_mask:0x1
  v_add_f32_dpp v190, v27, v189 wave_shr:1 row_mask:0xf bank_mask:0xf
  v_add_f32_dpp v177, v178, v176 wave_shr:1 row_mask:0xf bank_mask:0xf bound_ctrl:0
  v_add_f32_dpp v181, v178, v180 wave_ror:1 row_mask:0x1 bank_mask:0x1
  v_add_f32_dpp v181, v182, v180 wave_shr:1 row_mask:0xf bank_mask:0xf
  v_add_f32_dpp v185, v182, v184 wave_ror:1 row_mask:0x1 bank_mask:0x1
  v_add_f32_dpp v185, v186, v184 wave_shr:1 row_mask:0xf bank_mask:0xf
  v_add_f32_dpp v189, v186, v188 wave_ror:1 row_mask:0x1 bank_mask:0x1
  v_add_f32_dpp v189, v190, v188 wave_shr:1 row_mask:0xf bank_mask:0xf
  s_mov_b32 m0, s47
  s_nop 0
  ds_write_addtid_b32 v177 offset:29120
  ds_write_addtid_b32 v181 offset:29376
  ds_write_addtid_b32 v185 offset:29632
  ds_write_addtid_b32 v189 offset:29888
  s_mov_b64 exec, s[40:41]
  ds_write_addtid_b32 v190 offset:29892
  ds_write_addtid_b32 v27 offset:29896
  ds_write_addtid_b32 v191 offset:29900
  s_mov_b64 exec, -1
  s_waitcnt lgkmcnt(0)
  s_barrier
  s_setprio 0
  ds_read_b32 v48, v5 offset:29120
  ds_read_b32 v49, v5 offset:30160
  ds_read_b32 v50, v5 offset:31200
  ds_read_b32 v51, v5 offset:32240
  v_mov_b32 v52, 0
  v_mov_b32 v53, 0
  v_mov_b32 v54, 0
  v_mov_b32 v55, 0
  s_mov_b64 exec, s[42:43]
  ds_read_b32 v52, v6 offset:24960
  ds_read_b32 v53, v6 offset:26000
  ds_read_b32 v54, v6 offset:27040
  ds_read_b32 v55, v6 offset:28080
  s_mov_b64 exec, -1
  s_waitcnt lgkmcnt(3)
  v_fmac_f32 v48, s38, v52
  s_waitcnt lgkmcnt(2)
  v_fmac_f32 v49, s38, v53
  s_waitcnt lgkmcnt(1)
  v_fmac_f32 v50, s38, v54
  s_waitcnt lgkmcnt(0)
  v_fmac_f32 v51, s38, v55
  v_cvt_pk_bf16_f32 v56, v48, v49
  v_cvt_pk_bf16_f32 v57, v50, v51
  s_mov_b32 s46, 4587520
  buffer_store_dwordx2 v[56:57], v10, s[12:15], s46 offen
  s_branch L_END
L_END:
L_EXIT:
  s_endpgm
L_CODE_END:
.section .rodata,"a"
.p2align 6
.amdhsa_kernel concat_heads__ssm_conv_s4d__ssm_conv_h3__prompt_kernel
  .amdhsa_next_free_vgpr 256
  .amdhsa_next_free_sgpr 102
  .amdhsa_accum_offset 192
  .amdhsa_group_segment_fixed_size 0
  .amdhsa_kernarg_size 128
  .amdhsa_user_sgpr_count 2
  .amdhsa_user_sgpr_kernarg_segment_ptr 1
  .amdhsa_system_sgpr_workgroup_id_x 1
.end_amdhsa_kernel
```
